```python
import torch

def _softmax(x, axis=-1):
    return torch.softmax(x, dim=axis)

def _gelu(x):
    return torch.nn.functional.gelu(x, approximate='tanh')

def _silu(x):
    return torch.nn.functional.silu(x)

def _sigmoid(x):
    return torch.sigmoid(x)

def _layernorm(x, axis=-1, eps=1e-05):
    m = x.mean(dim=axis, keepdim=True)
    v = x.var(dim=axis, keepdim=True, unbiased=False)
    return (x - m) / torch.sqrt(v + eps)

def _scatter_add(tgt, idx, src, axis=0):
    return tgt.clone().index_add_(axis, idx, src)

def _segment_sum(src, seg, n):
    out = torch.zeros((n,) + src.shape[1:], dtype=src.dtype)
    return out.index_add_(0, seg, src)

def _pad(x, pw):
    flat = tuple((v for pair in reversed(pw) for v in pair))
    return torch.nn.functional.pad(x, flat)
kernel_name = 'adaLN_cond__sliding_block__glu_gated_glu__prompt'

def setup_inputs():

    _w = lambda a: (lambda t: t.to(torch.bfloat16) if t.is_floating_point() else t)(torch.as_tensor(a))

    def _A_setup():
        B, S, D = (1, 2048, 512)
        return {'x': _w((lambda *s: torch.randn(*s, dtype=torch.bfloat16) * 0.05)(B, S, D)), 'wqkv': _w((lambda *s: torch.randn(*s, dtype=torch.bfloat16) * 0.05)(D, 3 * D)), 'wo': _w((lambda *s: torch.randn(*s, dtype=torch.bfloat16) * 0.05)(D, D))}
    _A_in = _A_setup()

    def _B_setup():
        B, S, D, F = (1, 2048, 512, 1792)
        return {'x': _w((lambda *s: torch.randn(*s, dtype=torch.bfloat16) * 0.05)(B, S, D)), 'w_gate': _w((lambda *s: torch.randn(*s, dtype=torch.bfloat16) * 0.05)(D, F)), 'w_up': _w((lambda *s: torch.randn(*s, dtype=torch.bfloat16) * 0.05)(D, F)), 'w_down': _w((lambda *s: torch.randn(*s, dtype=torch.bfloat16) * 0.05)(F, D))}
    _B_in = _B_setup()
    return {'A_x': _A_in['x'], 'A_wqkv': _A_in['wqkv'], 'A_wo': _A_in['wo'], 'B_x': _B_in['x'], 'B_w_gate': _B_in['w_gate'], 'B_w_up': _B_in['w_up'], 'B_w_down': _B_in['w_down'], 'c': _w((lambda *s: torch.randn(*s, dtype=torch.bfloat16) * 0.1)(1, 512) * 8.0), 'w_mod': _w((lambda *s: torch.randn(*s, dtype=torch.bfloat16) * 0.1)(512, 6 * 512) * 512 ** (-0.5) * 8.0)}

def reference(A_x, A_wqkv, A_wo, B_x, B_w_gate, B_w_up, B_w_down, c, w_mod):

    def _A_ref(x, wqkv, wo):
        B, S, D = x.shape
        H = 32
        Dh = D // H
        W = 256
        qkv = (lambda x, *d: x.permute(*d))((x @ wqkv).reshape(B, S, 3, H, Dh), 2, 0, 3, 1, 4)
        q, k, v = (qkv[0], qkv[1], qkv[2])
        scores = torch.einsum('bhqd,bhkd->bhqk', q, k) * Dh ** (-0.5)
        idx = torch.arange(S)
        mask = (idx[:, None] - idx[None, :] >= 0) & (idx[:, None] - idx[None, :] < W)
        scores = torch.where(mask[None, None], scores, -1000000000.0)
        p = _softmax(scores, axis=-1)
        o = torch.einsum('bhqk,bhkd->bhqd', p, v)
        return (lambda x, *d: x.permute(*d))(o, 0, 2, 1, 3).reshape(B, S, D) @ wo

    def _B_ref(x, w_gate, w_up, w_down):
        g = torch.einsum('bsd,df->bsf', x, w_gate)
        u = torch.einsum('bsd,df->bsf', x, w_up)
        h = _sigmoid(g) * u
        return torch.einsum('bsf,fd->bsd', h, w_down)
    x = A_x
    mod = (_silu(c) @ w_mod).reshape(c.shape[0], 6, 1, -1)
    sa, ca, ga, sb, cb, gb = (mod[:, 0].clone(), mod[:, 1].clone(), mod[:, 2].clone(), mod[:, 3].clone(), mod[:, 4].clone(), mod[:, 5].clone())
    h = _layernorm(x, axis=-1) * (1 + ca) + sa
    x = x + ga * _A_ref(h, A_wqkv, A_wo)
    h = _layernorm(x, axis=-1) * (1 + cb) + sb
    x = x + gb * _B_ref(h, B_w_gate, B_w_up, B_w_down)
    return x
```

```asm
; @launch grid=(256,1,1) block=(512,1,1) lds=163840
.amdgcn_target "amdgcn-amd-amdhsa--gfx950"
.text
.globl adaLN_cond__sliding_block__glu_gated_glu__prompt_kernel
.p2align 8
.type adaLN_cond__sliding_block__glu_gated_glu__prompt_kernel,@function
adaLN_cond__sliding_block__glu_gated_glu__prompt_kernel:
  s_cmp_ge_u32 s2, 256
  s_cbranch_scc1 pb_kernel_end
  s_load_dwordx2 s[16:17], s[0:1], 88
  s_load_dwordx2 s[20:21], s[0:1], 0
  s_load_dwordx2 s[40:41], s[0:1], 8
  s_mov_b32 s18, 31457280
  s_mov_b32 s19, 0x20000
  s_mov_b32 s22, 2097152
  s_mov_b32 s23, 0x20000
  s_mov_b32 s42, 1572864
  s_mov_b32 s43, 0x20000
  v_and_b32 v1, 63, v0
  v_lshrrev_b32 v4, 6, v0
  v_and_b32 v2, 15, v0
  v_readfirstlane_b32 s4, v4
  v_bfe_u32 v3, v0, 4, 2
  s_and_b32 s27, s2, 1
  s_lshl_b32 s44, s27, 3
  s_bfe_u32 s27, s2, 196611
  s_add_u32 s44, s44, s27
  s_bfe_u32 s27, s2, 131073
  s_lshl_b32 s45, s27, 2
  s_lshr_b32 s27, s2, 6
  s_add_u32 s45, s45, s27
  s_and_b32 s46, s4, 3
  s_lshr_b32 s47, s4, 2
  s_lshl_b32 s48, s44, 2
  s_add_u32 s48, s48, s46
  s_lshl_b32 s48, s48, 15
  s_lshl_b32 s27, s47, 9
  s_add_u32 s48, s48, s27
  v_and_b32 v10, 31, v1
  v_lshrrev_b32 v12, 5, v1
  v_xor_b32 v11, v10, v12
  v_lshlrev_b32 v11, 4, v11
  v_lshl_add_u32 v11, v12, 10, v11
  s_lshl_b32 s49, s4, 14
  s_mov_b32 s55, -1
  s_waitcnt lgkmcnt(0)
  s_load_dword s60, s[16:17], 32768
  s_cmp_lg_u32 s4, 6
  s_cbranch_scc1 p0_ng
  s_cmp_ge_u32 s2, 192
  s_cbranch_scc1 p0_ng
  s_setprio 3
  s_load_dwordx2 s[8:9], s[0:1], 64
  s_load_dwordx2 s[12:13], s[0:1], 56
  s_mov_b32 s10, 3145728
  s_mov_b32 s11, 0x20000
  s_mov_b32 s14, 1024
  s_mov_b32 s15, 0x20000
  s_and_b32 s24, s2, 7
  s_lshl_b32 s24, s24, 3
  s_bfe_u32 s25, s2, 0x30003
  s_add_u32 s24, s24, s25
  s_and_b32 s25, s2, 0xc0
  s_add_u32 s24, s24, s25
  s_lshl_b32 s25, s24, 5
  v_lshrrev_b32 v5, 1, v1
  v_mul_u32_u24 v5, 6144, v5
  v_and_b32 v6, 1, v1
  v_lshl_add_u32 v5, v6, 4, v5
  v_lshlrev_b32 v8, 4, v1
  s_waitcnt lgkmcnt(0)
  buffer_load_dwordx4 v[16:19], v8, s[12:15], 0 offen
  s_mov_b32 m0, 131072
  s_add_u32 s7, s25, 0
  buffer_load_dwordx4 v5, s[8:11], s7 offen lds
  s_mov_b32 m0, 132096
  s_add_u32 s7, s25, 196608
  buffer_load_dwordx4 v5, s[8:11], s7 offen lds
  s_mov_b32 m0, 133120
  s_add_u32 s7, s25, 393216
  buffer_load_dwordx4 v5, s[8:11], s7 offen lds
  s_mov_b32 m0, 134144
  s_add_u32 s7, s25, 589824
  buffer_load_dwordx4 v5, s[8:11], s7 offen lds
  s_mov_b32 m0, 135168
  s_add_u32 s7, s25, 786432
  buffer_load_dwordx4 v5, s[8:11], s7 offen lds
  s_mov_b32 m0, 136192
  s_add_u32 s7, s25, 983040
  buffer_load_dwordx4 v5, s[8:11], s7 offen lds
  s_mov_b32 m0, 137216
  s_add_u32 s7, s25, 1179648
  buffer_load_dwordx4 v5, s[8:11], s7 offen lds
  s_mov_b32 m0, 138240
  s_add_u32 s7, s25, 1376256
  buffer_load_dwordx4 v5, s[8:11], s7 offen lds
  s_mov_b32 m0, 139264
  s_add_u32 s7, s25, 1572864
  buffer_load_dwordx4 v5, s[8:11], s7 offen lds
  s_mov_b32 m0, 140288
  s_add_u32 s7, s25, 1769472
  buffer_load_dwordx4 v5, s[8:11], s7 offen lds
  s_mov_b32 m0, 141312
  s_add_u32 s7, s25, 1966080
  buffer_load_dwordx4 v5, s[8:11], s7 offen lds
  s_mov_b32 m0, 142336
  s_add_u32 s7, s25, 2162688
  buffer_load_dwordx4 v5, s[8:11], s7 offen lds
  s_mov_b32 m0, 143360
  s_add_u32 s7, s25, 2359296
  buffer_load_dwordx4 v5, s[8:11], s7 offen lds
  s_mov_b32 m0, 144384
  s_add_u32 s7, s25, 2555904
  buffer_load_dwordx4 v5, s[8:11], s7 offen lds
  s_mov_b32 m0, 145408
  s_add_u32 s7, s25, 2752512
  buffer_load_dwordx4 v5, s[8:11], s7 offen lds
  s_mov_b32 m0, 146432
  s_add_u32 s7, s25, 2949120
  buffer_load_dwordx4 v5, s[8:11], s7 offen lds
  s_barrier
  s_mul_i32 s60, s60, 0x9e3779b1
  s_add_u32 s60, s60, 0x7f4a7c15
  s_waitcnt vmcnt(16)
  s_mov_b32 s27, 0xbfb8aa3b
  v_lshlrev_b32 v32, 16, v16
  v_and_b32 v33, 0xffff0000, v16
  v_mul_f32 v34, s27, v32
  v_mul_f32 v35, s27, v33
  v_exp_f32 v34, v34
  v_exp_f32 v35, v35
  s_nop 0
  v_add_f32 v34, 1.0, v34
  v_add_f32 v35, 1.0, v35
  v_rcp_f32 v34, v34
  v_rcp_f32 v35, v35
  s_nop 0
  v_mul_f32 v34, v34, v32
  v_mul_f32 v35, v35, v33
  v_cvt_pk_bf16_f32 v16, v34, v35
  v_lshlrev_b32 v32, 16, v17
  v_and_b32 v33, 0xffff0000, v17
  v_mul_f32 v34, s27, v32
  v_mul_f32 v35, s27, v33
  v_exp_f32 v34, v34
  v_exp_f32 v35, v35
  s_nop 0
  v_add_f32 v34, 1.0, v34
  v_add_f32 v35, 1.0, v35
  v_rcp_f32 v34, v34
  v_rcp_f32 v35, v35
  s_nop 0
  v_mul_f32 v34, v34, v32
  v_mul_f32 v35, v35, v33
  v_cvt_pk_bf16_f32 v17, v34, v35
  v_lshlrev_b32 v32, 16, v18
  v_and_b32 v33, 0xffff0000, v18
  v_mul_f32 v34, s27, v32
  v_mul_f32 v35, s27, v33
  v_exp_f32 v34, v34
  v_exp_f32 v35, v35
  s_nop 0
  v_add_f32 v34, 1.0, v34
  v_add_f32 v35, 1.0, v35
  v_rcp_f32 v34, v34
  v_rcp_f32 v35, v35
  s_nop 0
  v_mul_f32 v34, v34, v32
  v_mul_f32 v35, v35, v33
  v_cvt_pk_bf16_f32 v18, v34, v35
  v_lshlrev_b32 v32, 16, v19
  v_and_b32 v33, 0xffff0000, v19
  v_mul_f32 v34, s27, v32
  v_mul_f32 v35, s27, v33
  v_exp_f32 v34, v34
  v_exp_f32 v35, v35
  s_nop 0
  v_add_f32 v34, 1.0, v34
  v_add_f32 v35, 1.0, v35
  v_rcp_f32 v34, v34
  v_rcp_f32 v35, v35
  s_nop 0
  v_mul_f32 v34, v34, v32
  v_mul_f32 v35, v35, v33
  v_cvt_pk_bf16_f32 v19, v34, v35
  v_add_u32 v8, 131072, v8
  v_lshlrev_b32 v9, 4, v3
  v_add_u32 v9, 131072, v9
  v_lshrrev_b32 v6, 2, v2
  v_lshl_add_u32 v6, v3, 3, v6
  v_lshlrev_b32 v6, 5, v6
  v_and_b32 v7, 3, v2
  v_lshl_add_u32 v6, v7, 3, v6
  v_add_u32 v6, 131072, v6
  ds_write_b128 v8, v[16:19] offset:16384
  s_waitcnt lgkmcnt(0)
  ds_read_b128 v[128:131], v9 offset:16384
  ds_read_b128 v[132:135], v9 offset:16448
  ds_read_b128 v[136:139], v9 offset:16512
  ds_read_b128 v[140:143], v9 offset:16576
  ds_read_b128 v[144:147], v9 offset:16640
  ds_read_b128 v[148:151], v9 offset:16704
  ds_read_b128 v[152:155], v9 offset:16768
  ds_read_b128 v[156:159], v9 offset:16832
  ds_read_b128 v[160:163], v9 offset:16896
  ds_read_b128 v[164:167], v9 offset:16960
  ds_read_b128 v[168:171], v9 offset:17024
  ds_read_b128 v[172:175], v9 offset:17088
  ds_read_b128 v[176:179], v9 offset:17152
  ds_read_b128 v[180:183], v9 offset:17216
  ds_read_b128 v[184:187], v9 offset:17280
  ds_read_b128 v[188:191], v9 offset:17344
  s_waitcnt vmcnt(0)
  ds_read_b64_tr_b16 v[192:193], v6 offset:0
  ds_read_b64_tr_b16 v[194:195], v6 offset:128
  ds_read_b64_tr_b16 v[196:197], v6 offset:1024
  ds_read_b64_tr_b16 v[198:199], v6 offset:1152
  ds_read_b64_tr_b16 v[200:201], v6 offset:2048
  ds_read_b64_tr_b16 v[202:203], v6 offset:2176
  ds_read_b64_tr_b16 v[204:205], v6 offset:3072
  ds_read_b64_tr_b16 v[206:207], v6 offset:3200
  ds_read_b64_tr_b16 v[208:209], v6 offset:4096
  ds_read_b64_tr_b16 v[210:211], v6 offset:4224
  ds_read_b64_tr_b16 v[212:213], v6 offset:5120
  ds_read_b64_tr_b16 v[214:215], v6 offset:5248
  ds_read_b64_tr_b16 v[216:217], v6 offset:6144
  ds_read_b64_tr_b16 v[218:219], v6 offset:6272
  ds_read_b64_tr_b16 v[220:221], v6 offset:7168
  ds_read_b64_tr_b16 v[222:223], v6 offset:7296
  ds_read_b64_tr_b16 v[224:225], v6 offset:8192
  ds_read_b64_tr_b16 v[226:227], v6 offset:8320
  ds_read_b64_tr_b16 v[228:229], v6 offset:9216
  ds_read_b64_tr_b16 v[230:231], v6 offset:9344
  ds_read_b64_tr_b16 v[232:233], v6 offset:10240
  ds_read_b64_tr_b16 v[234:235], v6 offset:10368
  ds_read_b64_tr_b16 v[236:237], v6 offset:11264
  ds_read_b64_tr_b16 v[238:239], v6 offset:11392
  ds_read_b64_tr_b16 v[240:241], v6 offset:12288
  ds_read_b64_tr_b16 v[242:243], v6 offset:12416
  ds_read_b64_tr_b16 v[244:245], v6 offset:13312
  ds_read_b64_tr_b16 v[246:247], v6 offset:13440
  ds_read_b64_tr_b16 v[248:249], v6 offset:14336
  ds_read_b64_tr_b16 v[250:251], v6 offset:14464
  ds_read_b64_tr_b16 v[252:253], v6 offset:15360
  ds_read_b64_tr_b16 v[254:255], v6 offset:15488
  s_waitcnt lgkmcnt(15)
  v_mfma_f32_16x16x32_bf16 v[40:43], v[192:195], v[128:131], 0
  v_mfma_f32_16x16x32_bf16 v[40:43], v[196:199], v[132:135], v[40:43]
  v_mfma_f32_16x16x32_bf16 v[40:43], v[200:203], v[136:139], v[40:43]
  v_mfma_f32_16x16x32_bf16 v[40:43], v[204:207], v[140:143], v[40:43]
  v_mfma_f32_16x16x32_bf16 v[40:43], v[208:211], v[144:147], v[40:43]
  v_mfma_f32_16x16x32_bf16 v[40:43], v[212:215], v[148:151], v[40:43]
  v_mfma_f32_16x16x32_bf16 v[40:43], v[216:219], v[152:155], v[40:43]
  v_mfma_f32_16x16x32_bf16 v[40:43], v[220:223], v[156:159], v[40:43]
  s_waitcnt lgkmcnt(14)
  v_mfma_f32_16x16x32_bf16 v[40:43], v[224:227], v[160:163], v[40:43]
  s_waitcnt lgkmcnt(12)
  v_mfma_f32_16x16x32_bf16 v[40:43], v[228:231], v[164:167], v[40:43]
  s_waitcnt lgkmcnt(10)
  v_mfma_f32_16x16x32_bf16 v[40:43], v[232:235], v[168:171], v[40:43]
  s_waitcnt lgkmcnt(8)
  v_mfma_f32_16x16x32_bf16 v[40:43], v[236:239], v[172:175], v[40:43]
  s_waitcnt lgkmcnt(6)
  v_mfma_f32_16x16x32_bf16 v[40:43], v[240:243], v[176:179], v[40:43]
  s_waitcnt lgkmcnt(4)
  v_mfma_f32_16x16x32_bf16 v[40:43], v[244:247], v[180:183], v[40:43]
  s_waitcnt lgkmcnt(2)
  v_mfma_f32_16x16x32_bf16 v[40:43], v[248:251], v[184:187], v[40:43]
  s_waitcnt lgkmcnt(0)
  v_mfma_f32_16x16x32_bf16 v[40:43], v[252:255], v[188:191], v[40:43]
  s_nop 7
  v_cvt_pk_bf16_f32 v40, v40, v40
  v_and_b32 v40, 0xffff0000, v40
  v_cvt_pk_bf16_f32 v41, v41, v41
  v_and_b32 v41, 0xffff0000, v41
  v_cvt_pk_bf16_f32 v42, v42, v42
  v_and_b32 v42, 0xffff0000, v42
  v_cvt_pk_bf16_f32 v43, v43, v43
  v_and_b32 v43, 0xffff0000, v43
  s_lshr_b32 s26, s24, 5
  s_cmp_eq_u32 s26, 1
  s_cselect_b32 s27, 1.0, 0
  s_cmp_eq_u32 s26, 4
  s_cselect_b32 s27, 1.0, s27
  v_add_f32 v40, s27, v40
  v_cvt_pk_bf16_f32 v40, v40, v40
  v_and_b32 v40, 0xffff0000, v40
  v_add_f32 v41, s27, v41
  v_cvt_pk_bf16_f32 v41, v41, v41
  v_and_b32 v41, 0xffff0000, v41
  v_add_f32 v42, s27, v42
  v_cvt_pk_bf16_f32 v42, v42, v42
  v_and_b32 v42, 0xffff0000, v42
  v_add_f32 v43, s27, v43
  v_cvt_pk_bf16_f32 v43, v43, v43
  v_and_b32 v43, 0xffff0000, v43
  v_lshlrev_b32 v8, 4, v3
  s_lshl_b32 s26, s24, 6
  v_cmp_eq_u32 vcc, 0, v2
  s_and_saveexec_b64 s[28:29], vcc
  buffer_store_dwordx4 v[40:43], v8, s[16:19], s26 offen sc1
  v_cvt_pk_bf16_f32 v44, v40, v41
  v_cvt_pk_bf16_f32 v45, v42, v43
  v_lshlrev_b32 v8, 3, v3
  s_lshl_b32 s26, s24, 5
  s_add_u32 s26, s26, 16384
  buffer_store_dwordx2 v[44:45], v8, s[16:19], s26 offen sc1
  s_mov_b64 exec, -1
  s_cmp_ge_u32 s24, 64
  s_cbranch_scc1 p0_gx
  v_mov_b32 v9, s60
  v_mov_b32 v8, 31064064
  s_lshl_b32 s27, s24, 7
  s_mov_b64 exec, 1
  s_waitcnt vmcnt(0)
  buffer_store_dword v9, v8, s[16:19], s27 offen sc1
  s_mov_b64 exec, -1
p0_gx:
  s_add_u32 m0, s49, 0
  s_add_u32 s39, s48, 0
  v_xor_b32 v14, 0, v11
  buffer_load_dwordx4 v14, s[20:23], s39 offen lds
  s_add_u32 m0, s49, 1024
  s_add_u32 s39, s48, 2048
  v_xor_b32 v14, 32, v11
  buffer_load_dwordx4 v14, s[20:23], s39 offen lds
  s_add_u32 m0, s49, 2048
  s_add_u32 s39, s48, 4096
  v_xor_b32 v14, 64, v11
  buffer_load_dwordx4 v14, s[20:23], s39 offen lds
  s_add_u32 m0, s49, 3072
  s_add_u32 s39, s48, 6144
  v_xor_b32 v14, 96, v11
  buffer_load_dwordx4 v14, s[20:23], s39 offen lds
  s_add_u32 m0, s49, 4096
  s_add_u32 s39, s48, 8192
  v_xor_b32 v14, 128, v11
  buffer_load_dwordx4 v14, s[20:23], s39 offen lds
  s_add_u32 m0, s49, 5120
  s_add_u32 s39, s48, 10240
  v_xor_b32 v14, 160, v11
  buffer_load_dwordx4 v14, s[20:23], s39 offen lds
  s_add_u32 m0, s49, 6144
  s_add_u32 s39, s48, 12288
  v_xor_b32 v14, 192, v11
  buffer_load_dwordx4 v14, s[20:23], s39 offen lds
  s_add_u32 m0, s49, 7168
  s_add_u32 s39, s48, 14336
  v_xor_b32 v14, 224, v11
  buffer_load_dwordx4 v14, s[20:23], s39 offen lds
  s_add_u32 m0, s49, 8192
  s_add_u32 s39, s48, 16384
  v_xor_b32 v14, 0, v11
  buffer_load_dwordx4 v14, s[20:23], s39 offen lds
  s_add_u32 m0, s49, 9216
  s_add_u32 s39, s48, 18432
  v_xor_b32 v14, 32, v11
  buffer_load_dwordx4 v14, s[20:23], s39 offen lds
  s_add_u32 m0, s49, 10240
  s_add_u32 s39, s48, 20480
  v_xor_b32 v14, 64, v11
  buffer_load_dwordx4 v14, s[20:23], s39 offen lds
  s_add_u32 m0, s49, 11264
  s_add_u32 s39, s48, 22528
  v_xor_b32 v14, 96, v11
  buffer_load_dwordx4 v14, s[20:23], s39 offen lds
  s_add_u32 m0, s49, 12288
  s_add_u32 s39, s48, 24576
  v_xor_b32 v14, 128, v11
  buffer_load_dwordx4 v14, s[20:23], s39 offen lds
  s_add_u32 m0, s49, 13312
  s_add_u32 s39, s48, 26624
  v_xor_b32 v14, 160, v11
  buffer_load_dwordx4 v14, s[20:23], s39 offen lds
  s_add_u32 m0, s49, 14336
  s_add_u32 s39, s48, 28672
  v_xor_b32 v14, 192, v11
  buffer_load_dwordx4 v14, s[20:23], s39 offen lds
  s_add_u32 m0, s49, 15360
  s_add_u32 s39, s48, 30720
  v_xor_b32 v14, 224, v11
  buffer_load_dwordx4 v14, s[20:23], s39 offen lds
  s_waitcnt vmcnt(0)
  s_branch p0_s2
p0_ng:
  s_and_b32 s38, s44, 7
  s_mul_i32 s38, s38, 196608
  s_lshl_b32 s39, s45, 6
  s_add_u32 s38, s38, s39
  v_mul_u32_u24 v5, 3072, v1
  s_cmp_lg_u32 s4, 7
  s_cbranch_scc1 p0_nt
  buffer_load_dword v59, v5, s[40:43], s38 offen offset:0
  buffer_load_dword v60, v5, s[40:43], s38 offen offset:1024
  buffer_load_dword v61, v5, s[40:43], s38 offen offset:2048
p0_nt:
  s_barrier
  s_add_u32 m0, s49, 0
  s_add_u32 s39, s48, 0
  v_xor_b32 v14, 0, v11
  buffer_load_dwordx4 v14, s[20:23], s39 offen lds
  s_add_u32 m0, s49, 1024
  s_add_u32 s39, s48, 2048
  v_xor_b32 v14, 32, v11
  buffer_load_dwordx4 v14, s[20:23], s39 offen lds
  s_add_u32 m0, s49, 2048
  s_add_u32 s39, s48, 4096
  v_xor_b32 v14, 64, v11
  buffer_load_dwordx4 v14, s[20:23], s39 offen lds
  s_add_u32 m0, s49, 3072
  s_add_u32 s39, s48, 6144
  v_xor_b32 v14, 96, v11
  buffer_load_dwordx4 v14, s[20:23], s39 offen lds
  s_add_u32 m0, s49, 4096
  s_add_u32 s39, s48, 8192
  v_xor_b32 v14, 128, v11
  buffer_load_dwordx4 v14, s[20:23], s39 offen lds
  s_add_u32 m0, s49, 5120
  s_add_u32 s39, s48, 10240
  v_xor_b32 v14, 160, v11
  buffer_load_dwordx4 v14, s[20:23], s39 offen lds
  s_add_u32 m0, s49, 6144
  s_add_u32 s39, s48, 12288
  v_xor_b32 v14, 192, v11
  buffer_load_dwordx4 v14, s[20:23], s39 offen lds
  s_add_u32 m0, s49, 7168
  s_add_u32 s39, s48, 14336
  v_xor_b32 v14, 224, v11
  buffer_load_dwordx4 v14, s[20:23], s39 offen lds
  s_add_u32 m0, s49, 8192
  s_add_u32 s39, s48, 16384
  v_xor_b32 v14, 0, v11
  buffer_load_dwordx4 v14, s[20:23], s39 offen lds
  s_add_u32 m0, s49, 9216
  s_add_u32 s39, s48, 18432
  v_xor_b32 v14, 32, v11
  buffer_load_dwordx4 v14, s[20:23], s39 offen lds
  s_add_u32 m0, s49, 10240
  s_add_u32 s39, s48, 20480
  v_xor_b32 v14, 64, v11
  buffer_load_dwordx4 v14, s[20:23], s39 offen lds
  s_add_u32 m0, s49, 11264
  s_add_u32 s39, s48, 22528
  v_xor_b32 v14, 96, v11
  buffer_load_dwordx4 v14, s[20:23], s39 offen lds
  s_add_u32 m0, s49, 12288
  s_add_u32 s39, s48, 24576
  v_xor_b32 v14, 128, v11
  buffer_load_dwordx4 v14, s[20:23], s39 offen lds
  s_add_u32 m0, s49, 13312
  s_add_u32 s39, s48, 26624
  v_xor_b32 v14, 160, v11
  buffer_load_dwordx4 v14, s[20:23], s39 offen lds
  s_add_u32 m0, s49, 14336
  s_add_u32 s39, s48, 28672
  v_xor_b32 v14, 192, v11
  buffer_load_dwordx4 v14, s[20:23], s39 offen lds
  s_add_u32 m0, s49, 15360
  s_add_u32 s39, s48, 30720
  v_xor_b32 v14, 224, v11
  buffer_load_dwordx4 v14, s[20:23], s39 offen lds
  s_waitcnt vmcnt(0)
  s_waitcnt lgkmcnt(0)
  s_mul_i32 s60, s60, 0x9e3779b1
  s_add_u32 s60, s60, 0x7f4a7c15
p0_s2:
  v_and_b32 v14, 15, v10
  v_xor_b32 v14, v14, v12
  v_lshlrev_b32 v14, 4, v14
  v_lshl_add_u32 v14, v10, 9, v14
  v_add_u32 v14, s49, v14
  v_xor_b32 v15, 0, v14
  ds_read_b128 v[64:67], v15
  v_xor_b32 v15, 32, v14
  ds_read_b128 v[68:71], v15
  v_xor_b32 v15, 64, v14
  ds_read_b128 v[72:75], v15
  v_xor_b32 v15, 96, v14
  ds_read_b128 v[76:79], v15
  v_xor_b32 v15, 128, v14
  ds_read_b128 v[80:83], v15
  v_xor_b32 v15, 160, v14
  ds_read_b128 v[84:87], v15
  v_xor_b32 v15, 192, v14
  ds_read_b128 v[88:91], v15
  v_xor_b32 v15, 224, v14
  ds_read_b128 v[92:95], v15
  v_xor_b32 v15, 256, v14
  ds_read_b128 v[96:99], v15
  v_xor_b32 v15, 288, v14
  ds_read_b128 v[100:103], v15
  v_xor_b32 v15, 320, v14
  ds_read_b128 v[104:107], v15
  v_xor_b32 v15, 352, v14
  ds_read_b128 v[108:111], v15
  v_xor_b32 v15, 384, v14
  ds_read_b128 v[112:115], v15
  v_xor_b32 v15, 416, v14
  ds_read_b128 v[116:119], v15
  v_xor_b32 v15, 448, v14
  ds_read_b128 v[120:123], v15
  v_xor_b32 v15, 480, v14
  ds_read_b128 v[124:127], v15
  s_cmp_lt_u32 s4, 4
  s_cbranch_scc1 p0_nj
  s_cmp_eq_u32 s4, 6
  s_cbranch_scc1 p0_nj
  s_sub_u32 s20, 255, s2
  s_mul_i32 s20, s20, 3
  s_min_u32 s7, s46, 2
  s_add_u32 s20, s20, s7
  s_mov_b32 s7, s46
  s_cmp_ge_u32 s20, 736
  s_cbranch_scc1 p0_nj
  s_mov_b32 s30, 0
  s_cmp_ge_u32 s20, 448
  s_cbranch_scc1 pa_r2
  s_load_dwordx2 s[8:9], s[0:1], 32
  s_load_dwordx2 s[12:13], s[0:1], 40
  s_mov_b32 s10, 1835008
  s_mov_b32 s11, 0x20000
  s_mov_b32 s14, 1835008
  s_mov_b32 s15, 0x20000
  s_and_b32 s21, s20, 31
  s_lshr_b32 s22, s20, 5
  s_lshl_b32 s24, s22, 8
  s_mov_b32 s25, s24
  s_mov_b32 s26, 3584
  s_mul_i32 s27, s22, 262144
  s_lshl_b32 s23, s21, 10
  s_add_u32 s27, s27, s23
  s_add_u32 s27, s27, 2359296
  s_mov_b32 s28, 65536
  s_mov_b32 s37, 32768
  s_mov_b32 s29, 0
  s_mov_b32 s30, 1
  s_branch pa_go
pa_r2:
  s_sub_u32 s20, s20, 448
  s_mov_b32 s26, 1024
  s_mov_b32 s37, 1024
  s_mov_b32 s29, 1
  s_cmp_ge_u32 s20, 64
  s_cbranch_scc1 pa_r3
  s_load_dwordx2 s[8:9], s[0:1], 16
  s_mov_b32 s10, 524288
  s_mov_b32 s11, 0x20000
  s_load_dwordx2 s[12:13], s[0:1], 16
  s_mov_b32 s14, 524288
  s_mov_b32 s15, 0x20000
  s_mov_b32 s28, 65536
  s_mov_b32 s27, 1835008
  s_branch pa_r4
pa_r3:
  s_sub_u32 s20, s20, 64
  s_load_dwordx2 s[8:9], s[0:1], 48
  s_mov_b32 s10, 1835008
  s_mov_b32 s11, 0x20000
  s_load_dwordx2 s[12:13], s[0:1], 48
  s_mov_b32 s14, 1835008
  s_mov_b32 s15, 0x20000
  s_mov_b32 s28, 229376
  s_mov_b32 s27, 6029312
pa_r4:
  s_lshr_b32 s21, s20, 1
  s_and_b32 s22, s20, 1
  s_lshl_b32 s24, s22, 9
  s_add_u32 s25, s24, 256
  s_lshl_b32 s23, s22, 2
  s_mul_i32 s23, s23, s28
  s_add_u32 s27, s27, s23
  s_lshl_b32 s23, s21, 11
  s_add_u32 s27, s27, s23
pa_go:
  s_lshl_b32 s31, s26, 4
  s_mul_i32 s31, s31, s21
  s_add_u32 s24, s24, s31
  s_add_u32 s25, s25, s31
  s_lshl_b32 s31, s26, 2
  v_mul_lo_u32 v5, v3, s26
  v_lshl_add_u32 v5, v2, 4, v5
  s_lshl_b32 s6, s7, 13
  s_add_u32 s6, s6, 0x18000
  s_waitcnt lgkmcnt(0)
  v_bfe_u32 v6, v1, 1, 4
  v_mul_lo_u32 v6, v6, s26
  v_and_b32 v7, 1, v1
  v_lshl_add_u32 v6, v7, 7, v6
  v_mov_b32 v13, v5
  s_mov_b32 s55, s30
p0_nj:
  v_lshrrev_b32 v5, 2, v1
  v_mul_u32_u24 v5, 3072, v5
  v_and_b32 v6, 3, v1
  v_lshl_add_u32 v5, v6, 4, v5
  s_and_b32 s38, s4, 1
  s_mul_i32 s38, s38, 786432
  s_lshr_b32 s39, s4, 1
  s_lshl_b32 s39, s39, 10
  s_add_u32 s38, s38, s39
  s_lshl_b32 s39, s45, 6
  s_add_u32 s38, s38, s39
  s_waitcnt lgkmcnt(0)
  s_cmp_ge_u32 s4, 6
  s_cselect_b32 vcc_lo, 1, 0
  s_mov_b32 vcc_hi, 0
  v_mov_b32 v16, 0
  v_mov_b32 v17, 0
  v_mov_b32 v18, 0
  v_mov_b32 v19, 0
  s_add_u32 m0, s49, 0
  s_add_u32 s39, s38, 0
  s_cbranch_vccnz p0_w00
  buffer_load_dwordx4 v5, s[40:43], s39 offen lds
p0_w00:
  v_lshlrev_b32 v128, 16, v64
  v_and_b32 v129, 0xffff0000, v64
  v_pk_add_f32 v[16:17], v[16:17], v[128:129]
  v_pk_fma_f32 v[18:19], v[128:129], v[128:129], v[18:19]
  v_lshlrev_b32 v130, 16, v65
  v_and_b32 v131, 0xffff0000, v65
  v_pk_add_f32 v[16:17], v[16:17], v[130:131]
  v_pk_fma_f32 v[18:19], v[130:131], v[130:131], v[18:19]
  v_lshlrev_b32 v132, 16, v66
  v_and_b32 v133, 0xffff0000, v66
  v_pk_add_f32 v[16:17], v[16:17], v[132:133]
  v_pk_fma_f32 v[18:19], v[132:133], v[132:133], v[18:19]
  v_lshlrev_b32 v134, 16, v67
  v_and_b32 v135, 0xffff0000, v67
  v_pk_add_f32 v[16:17], v[16:17], v[134:135]
  v_pk_fma_f32 v[18:19], v[134:135], v[134:135], v[18:19]
  s_add_u32 m0, s49, 1024
  s_add_u32 s39, s38, 49152
  s_cbranch_vccnz p0_w04
  buffer_load_dwordx4 v5, s[40:43], s39 offen lds
p0_w04:
  v_lshlrev_b32 v136, 16, v68
  v_and_b32 v137, 0xffff0000, v68
  v_pk_add_f32 v[16:17], v[16:17], v[136:137]
  v_pk_fma_f32 v[18:19], v[136:137], v[136:137], v[18:19]
  v_lshlrev_b32 v138, 16, v69
  v_and_b32 v139, 0xffff0000, v69
  v_pk_add_f32 v[16:17], v[16:17], v[138:139]
  v_pk_fma_f32 v[18:19], v[138:139], v[138:139], v[18:19]
  v_lshlrev_b32 v140, 16, v70
  v_and_b32 v141, 0xffff0000, v70
  v_pk_add_f32 v[16:17], v[16:17], v[140:141]
  v_pk_fma_f32 v[18:19], v[140:141], v[140:141], v[18:19]
  v_lshlrev_b32 v142, 16, v71
  v_and_b32 v143, 0xffff0000, v71
  v_pk_add_f32 v[16:17], v[16:17], v[142:143]
  v_pk_fma_f32 v[18:19], v[142:143], v[142:143], v[18:19]
  s_add_u32 m0, s49, 2048
  s_add_u32 s39, s38, 98304
  s_cbranch_vccnz p0_w08
  buffer_load_dwordx4 v5, s[40:43], s39 offen lds
p0_w08:
  v_lshlrev_b32 v144, 16, v72
  v_and_b32 v145, 0xffff0000, v72
  v_pk_add_f32 v[16:17], v[16:17], v[144:145]
  v_pk_fma_f32 v[18:19], v[144:145], v[144:145], v[18:19]
  v_lshlrev_b32 v146, 16, v73
  v_and_b32 v147, 0xffff0000, v73
  v_pk_add_f32 v[16:17], v[16:17], v[146:147]
  v_pk_fma_f32 v[18:19], v[146:147], v[146:147], v[18:19]
  v_lshlrev_b32 v148, 16, v74
  v_and_b32 v149, 0xffff0000, v74
  v_pk_add_f32 v[16:17], v[16:17], v[148:149]
  v_pk_fma_f32 v[18:19], v[148:149], v[148:149], v[18:19]
  v_lshlrev_b32 v150, 16, v75
  v_and_b32 v151, 0xffff0000, v75
  v_pk_add_f32 v[16:17], v[16:17], v[150:151]
  v_pk_fma_f32 v[18:19], v[150:151], v[150:151], v[18:19]
  s_add_u32 m0, s49, 3072
  s_add_u32 s39, s38, 147456
  s_cbranch_vccnz p0_w012
  buffer_load_dwordx4 v5, s[40:43], s39 offen lds
p0_w012:
  v_lshlrev_b32 v152, 16, v76
  v_and_b32 v153, 0xffff0000, v76
  v_pk_add_f32 v[16:17], v[16:17], v[152:153]
  v_pk_fma_f32 v[18:19], v[152:153], v[152:153], v[18:19]
  v_lshlrev_b32 v154, 16, v77
  v_and_b32 v155, 0xffff0000, v77
  v_pk_add_f32 v[16:17], v[16:17], v[154:155]
  v_pk_fma_f32 v[18:19], v[154:155], v[154:155], v[18:19]
  v_lshlrev_b32 v156, 16, v78
  v_and_b32 v157, 0xffff0000, v78
  v_pk_add_f32 v[16:17], v[16:17], v[156:157]
  v_pk_fma_f32 v[18:19], v[156:157], v[156:157], v[18:19]
  v_lshlrev_b32 v158, 16, v79
  v_and_b32 v159, 0xffff0000, v79
  v_pk_add_f32 v[16:17], v[16:17], v[158:159]
  v_pk_fma_f32 v[18:19], v[158:159], v[158:159], v[18:19]
  s_add_u32 m0, s49, 4096
  s_add_u32 s39, s38, 196608
  s_cbranch_vccnz p0_w016
  buffer_load_dwordx4 v5, s[40:43], s39 offen lds
p0_w016:
  v_lshlrev_b32 v160, 16, v80
  v_and_b32 v161, 0xffff0000, v80
  v_pk_add_f32 v[16:17], v[16:17], v[160:161]
  v_pk_fma_f32 v[18:19], v[160:161], v[160:161], v[18:19]
  v_lshlrev_b32 v162, 16, v81
  v_and_b32 v163, 0xffff0000, v81
  v_pk_add_f32 v[16:17], v[16:17], v[162:163]
  v_pk_fma_f32 v[18:19], v[162:163], v[162:163], v[18:19]
  v_lshlrev_b32 v164, 16, v82
  v_and_b32 v165, 0xffff0000, v82
  v_pk_add_f32 v[16:17], v[16:17], v[164:165]
  v_pk_fma_f32 v[18:19], v[164:165], v[164:165], v[18:19]
  v_lshlrev_b32 v166, 16, v83
  v_and_b32 v167, 0xffff0000, v83
  v_pk_add_f32 v[16:17], v[16:17], v[166:167]
  v_pk_fma_f32 v[18:19], v[166:167], v[166:167], v[18:19]
  s_add_u32 m0, s49, 5120
  s_add_u32 s39, s38, 245760
  s_cbranch_vccnz p0_w020
  buffer_load_dwordx4 v5, s[40:43], s39 offen lds
p0_w020:
  v_lshlrev_b32 v168, 16, v84
  v_and_b32 v169, 0xffff0000, v84
  v_pk_add_f32 v[16:17], v[16:17], v[168:169]
  v_pk_fma_f32 v[18:19], v[168:169], v[168:169], v[18:19]
  v_lshlrev_b32 v170, 16, v85
  v_and_b32 v171, 0xffff0000, v85
  v_pk_add_f32 v[16:17], v[16:17], v[170:171]
  v_pk_fma_f32 v[18:19], v[170:171], v[170:171], v[18:19]
  v_lshlrev_b32 v172, 16, v86
  v_and_b32 v173, 0xffff0000, v86
  v_pk_add_f32 v[16:17], v[16:17], v[172:173]
  v_pk_fma_f32 v[18:19], v[172:173], v[172:173], v[18:19]
  v_lshlrev_b32 v174, 16, v87
  v_and_b32 v175, 0xffff0000, v87
  v_pk_add_f32 v[16:17], v[16:17], v[174:175]
  v_pk_fma_f32 v[18:19], v[174:175], v[174:175], v[18:19]
  s_add_u32 m0, s49, 6144
  s_add_u32 s39, s38, 294912
  s_cbranch_vccnz p0_w024
  buffer_load_dwordx4 v5, s[40:43], s39 offen lds
p0_w024:
  v_lshlrev_b32 v176, 16, v88
  v_and_b32 v177, 0xffff0000, v88
  v_pk_add_f32 v[16:17], v[16:17], v[176:177]
  v_pk_fma_f32 v[18:19], v[176:177], v[176:177], v[18:19]
  v_lshlrev_b32 v178, 16, v89
  v_and_b32 v179, 0xffff0000, v89
  v_pk_add_f32 v[16:17], v[16:17], v[178:179]
  v_pk_fma_f32 v[18:19], v[178:179], v[178:179], v[18:19]
  v_lshlrev_b32 v180, 16, v90
  v_and_b32 v181, 0xffff0000, v90
  v_pk_add_f32 v[16:17], v[16:17], v[180:181]
  v_pk_fma_f32 v[18:19], v[180:181], v[180:181], v[18:19]
  v_lshlrev_b32 v182, 16, v91
  v_and_b32 v183, 0xffff0000, v91
  v_pk_add_f32 v[16:17], v[16:17], v[182:183]
  v_pk_fma_f32 v[18:19], v[182:183], v[182:183], v[18:19]
  s_add_u32 m0, s49, 7168
  s_add_u32 s39, s38, 344064
  s_cbranch_vccnz p0_w028
  buffer_load_dwordx4 v5, s[40:43], s39 offen lds
p0_w028:
  v_lshlrev_b32 v184, 16, v92
  v_and_b32 v185, 0xffff0000, v92
  v_pk_add_f32 v[16:17], v[16:17], v[184:185]
  v_pk_fma_f32 v[18:19], v[184:185], v[184:185], v[18:19]
  v_lshlrev_b32 v186, 16, v93
  v_and_b32 v187, 0xffff0000, v93
  v_pk_add_f32 v[16:17], v[16:17], v[186:187]
  v_pk_fma_f32 v[18:19], v[186:187], v[186:187], v[18:19]
  v_lshlrev_b32 v188, 16, v94
  v_and_b32 v189, 0xffff0000, v94
  v_pk_add_f32 v[16:17], v[16:17], v[188:189]
  v_pk_fma_f32 v[18:19], v[188:189], v[188:189], v[18:19]
  v_lshlrev_b32 v190, 16, v95
  v_and_b32 v191, 0xffff0000, v95
  v_pk_add_f32 v[16:17], v[16:17], v[190:191]
  v_pk_fma_f32 v[18:19], v[190:191], v[190:191], v[18:19]
  s_add_u32 m0, s49, 8192
  s_add_u32 s39, s38, 393216
  s_cbranch_vccnz p0_w032
  buffer_load_dwordx4 v5, s[40:43], s39 offen lds
p0_w032:
  v_lshlrev_b32 v192, 16, v96
  v_and_b32 v193, 0xffff0000, v96
  v_pk_add_f32 v[16:17], v[16:17], v[192:193]
  v_pk_fma_f32 v[18:19], v[192:193], v[192:193], v[18:19]
  v_lshlrev_b32 v194, 16, v97
  v_and_b32 v195, 0xffff0000, v97
  v_pk_add_f32 v[16:17], v[16:17], v[194:195]
  v_pk_fma_f32 v[18:19], v[194:195], v[194:195], v[18:19]
  v_lshlrev_b32 v196, 16, v98
  v_and_b32 v197, 0xffff0000, v98
  v_pk_add_f32 v[16:17], v[16:17], v[196:197]
  v_pk_fma_f32 v[18:19], v[196:197], v[196:197], v[18:19]
  v_lshlrev_b32 v198, 16, v99
  v_and_b32 v199, 0xffff0000, v99
  v_pk_add_f32 v[16:17], v[16:17], v[198:199]
  v_pk_fma_f32 v[18:19], v[198:199], v[198:199], v[18:19]
  s_add_u32 m0, s49, 9216
  s_add_u32 s39, s38, 442368
  s_cbranch_vccnz p0_w036
  buffer_load_dwordx4 v5, s[40:43], s39 offen lds
p0_w036:
  v_lshlrev_b32 v200, 16, v100
  v_and_b32 v201, 0xffff0000, v100
  v_pk_add_f32 v[16:17], v[16:17], v[200:201]
  v_pk_fma_f32 v[18:19], v[200:201], v[200:201], v[18:19]
  v_lshlrev_b32 v202, 16, v101
  v_and_b32 v203, 0xffff0000, v101
  v_pk_add_f32 v[16:17], v[16:17], v[202:203]
  v_pk_fma_f32 v[18:19], v[202:203], v[202:203], v[18:19]
  v_lshlrev_b32 v204, 16, v102
  v_and_b32 v205, 0xffff0000, v102
  v_pk_add_f32 v[16:17], v[16:17], v[204:205]
  v_pk_fma_f32 v[18:19], v[204:205], v[204:205], v[18:19]
  v_lshlrev_b32 v206, 16, v103
  v_and_b32 v207, 0xffff0000, v103
  v_pk_add_f32 v[16:17], v[16:17], v[206:207]
  v_pk_fma_f32 v[18:19], v[206:207], v[206:207], v[18:19]
  s_add_u32 m0, s49, 10240
  s_add_u32 s39, s38, 491520
  s_cbranch_vccnz p0_w040
  buffer_load_dwordx4 v5, s[40:43], s39 offen lds
p0_w040:
  v_lshlrev_b32 v208, 16, v104
  v_and_b32 v209, 0xffff0000, v104
  v_pk_add_f32 v[16:17], v[16:17], v[208:209]
  v_pk_fma_f32 v[18:19], v[208:209], v[208:209], v[18:19]
  v_lshlrev_b32 v210, 16, v105
  v_and_b32 v211, 0xffff0000, v105
  v_pk_add_f32 v[16:17], v[16:17], v[210:211]
  v_pk_fma_f32 v[18:19], v[210:211], v[210:211], v[18:19]
  v_lshlrev_b32 v212, 16, v106
  v_and_b32 v213, 0xffff0000, v106
  v_pk_add_f32 v[16:17], v[16:17], v[212:213]
  v_pk_fma_f32 v[18:19], v[212:213], v[212:213], v[18:19]
  v_lshlrev_b32 v214, 16, v107
  v_and_b32 v215, 0xffff0000, v107
  v_pk_add_f32 v[16:17], v[16:17], v[214:215]
  v_pk_fma_f32 v[18:19], v[214:215], v[214:215], v[18:19]
  s_add_u32 m0, s49, 11264
  s_add_u32 s39, s38, 540672
  s_cbranch_vccnz p0_w044
  buffer_load_dwordx4 v5, s[40:43], s39 offen lds
p0_w044:
  v_lshlrev_b32 v216, 16, v108
  v_and_b32 v217, 0xffff0000, v108
  v_pk_add_f32 v[16:17], v[16:17], v[216:217]
  v_pk_fma_f32 v[18:19], v[216:217], v[216:217], v[18:19]
  v_lshlrev_b32 v218, 16, v109
  v_and_b32 v219, 0xffff0000, v109
  v_pk_add_f32 v[16:17], v[16:17], v[218:219]
  v_pk_fma_f32 v[18:19], v[218:219], v[218:219], v[18:19]
  v_lshlrev_b32 v220, 16, v110
  v_and_b32 v221, 0xffff0000, v110
  v_pk_add_f32 v[16:17], v[16:17], v[220:221]
  v_pk_fma_f32 v[18:19], v[220:221], v[220:221], v[18:19]
  v_lshlrev_b32 v222, 16, v111
  v_and_b32 v223, 0xffff0000, v111
  v_pk_add_f32 v[16:17], v[16:17], v[222:223]
  v_pk_fma_f32 v[18:19], v[222:223], v[222:223], v[18:19]
  s_add_u32 m0, s49, 12288
  s_add_u32 s39, s38, 589824
  s_cbranch_vccnz p0_w048
  buffer_load_dwordx4 v5, s[40:43], s39 offen lds
p0_w048:
  v_lshlrev_b32 v224, 16, v112
  v_and_b32 v225, 0xffff0000, v112
  v_pk_add_f32 v[16:17], v[16:17], v[224:225]
  v_pk_fma_f32 v[18:19], v[224:225], v[224:225], v[18:19]
  v_lshlrev_b32 v226, 16, v113
  v_and_b32 v227, 0xffff0000, v113
  v_pk_add_f32 v[16:17], v[16:17], v[226:227]
  v_pk_fma_f32 v[18:19], v[226:227], v[226:227], v[18:19]
  v_lshlrev_b32 v228, 16, v114
  v_and_b32 v229, 0xffff0000, v114
  v_pk_add_f32 v[16:17], v[16:17], v[228:229]
  v_pk_fma_f32 v[18:19], v[228:229], v[228:229], v[18:19]
  v_lshlrev_b32 v230, 16, v115
  v_and_b32 v231, 0xffff0000, v115
  v_pk_add_f32 v[16:17], v[16:17], v[230:231]
  v_pk_fma_f32 v[18:19], v[230:231], v[230:231], v[18:19]
  s_add_u32 m0, s49, 13312
  s_add_u32 s39, s38, 638976
  s_cbranch_vccnz p0_w052
  buffer_load_dwordx4 v5, s[40:43], s39 offen lds
p0_w052:
  v_lshlrev_b32 v232, 16, v116
  v_and_b32 v233, 0xffff0000, v116
  v_pk_add_f32 v[16:17], v[16:17], v[232:233]
  v_pk_fma_f32 v[18:19], v[232:233], v[232:233], v[18:19]
  v_lshlrev_b32 v234, 16, v117
  v_and_b32 v235, 0xffff0000, v117
  v_pk_add_f32 v[16:17], v[16:17], v[234:235]
  v_pk_fma_f32 v[18:19], v[234:235], v[234:235], v[18:19]
  v_lshlrev_b32 v236, 16, v118
  v_and_b32 v237, 0xffff0000, v118
  v_pk_add_f32 v[16:17], v[16:17], v[236:237]
  v_pk_fma_f32 v[18:19], v[236:237], v[236:237], v[18:19]
  v_lshlrev_b32 v238, 16, v119
  v_and_b32 v239, 0xffff0000, v119
  v_pk_add_f32 v[16:17], v[16:17], v[238:239]
  v_pk_fma_f32 v[18:19], v[238:239], v[238:239], v[18:19]
  s_add_u32 m0, s49, 14336
  s_add_u32 s39, s38, 688128
  s_cbranch_vccnz p0_w056
  buffer_load_dwordx4 v5, s[40:43], s39 offen lds
p0_w056:
  v_lshlrev_b32 v240, 16, v120
  v_and_b32 v241, 0xffff0000, v120
  v_pk_add_f32 v[16:17], v[16:17], v[240:241]
  v_pk_fma_f32 v[18:19], v[240:241], v[240:241], v[18:19]
  v_lshlrev_b32 v242, 16, v121
  v_and_b32 v243, 0xffff0000, v121
  v_pk_add_f32 v[16:17], v[16:17], v[242:243]
  v_pk_fma_f32 v[18:19], v[242:243], v[242:243], v[18:19]
  v_lshlrev_b32 v244, 16, v122
  v_and_b32 v245, 0xffff0000, v122
  v_pk_add_f32 v[16:17], v[16:17], v[244:245]
  v_pk_fma_f32 v[18:19], v[244:245], v[244:245], v[18:19]
  v_lshlrev_b32 v246, 16, v123
  v_and_b32 v247, 0xffff0000, v123
  v_pk_add_f32 v[16:17], v[16:17], v[246:247]
  v_pk_fma_f32 v[18:19], v[246:247], v[246:247], v[18:19]
  s_add_u32 m0, s49, 15360
  s_add_u32 s39, s38, 737280
  s_cbranch_vccnz p0_w060
  buffer_load_dwordx4 v5, s[40:43], s39 offen lds
p0_w060:
  v_lshlrev_b32 v248, 16, v124
  v_and_b32 v249, 0xffff0000, v124
  v_pk_add_f32 v[16:17], v[16:17], v[248:249]
  v_pk_fma_f32 v[18:19], v[248:249], v[248:249], v[18:19]
  v_lshlrev_b32 v250, 16, v125
  v_and_b32 v251, 0xffff0000, v125
  v_pk_add_f32 v[16:17], v[16:17], v[250:251]
  v_pk_fma_f32 v[18:19], v[250:251], v[250:251], v[18:19]
  v_lshlrev_b32 v252, 16, v126
  v_and_b32 v253, 0xffff0000, v126
  v_pk_add_f32 v[16:17], v[16:17], v[252:253]
  v_pk_fma_f32 v[18:19], v[252:253], v[252:253], v[18:19]
  v_lshlrev_b32 v254, 16, v127
  v_and_b32 v255, 0xffff0000, v127
  v_pk_add_f32 v[16:17], v[16:17], v[254:255]
  v_pk_fma_f32 v[18:19], v[254:255], v[254:255], v[18:19]
  v_add_f32 v16, v16, v17
  v_add_f32 v17, v18, v19
  v_lshlrev_b32 v8, 3, v0
  v_add_u32 v8, 153600, v8
  v_lshlrev_b32 v9, 3, v10
  s_lshl_b32 s39, s46, 9
  s_add_u32 s39, s39, 153600
  v_add_u32 v9, s39, v9
  ds_write_b64 v8, v[16:17]
  s_waitcnt lgkmcnt(0)
  s_setprio 0
  s_cmp_lg_u32 s4, 3
  s_cbranch_scc1 p0_mpe
  v_lshlrev_b32 v5, 7, v1
  v_add_u32 v5, 31064064, v5
  s_mov_b32 s50, 0x40000
p0_mp:
  buffer_load_dword v6, v5, s[16:19], 0 offen offset:0 sc1
  s_waitcnt vmcnt(0)
  v_cmp_ne_u32 vcc, s60, v6
  s_cbranch_vccz p0_mpe
  s_sleep 1
  s_sub_u32 s50, s50, 1
  s_cbranch_scc0 p0_mp
p0_mpe:
  s_barrier
  s_cmp_ge_u32 s4, 4
  s_cbranch_scc1 p0_nm
  s_lshl_b32 s39, s4, 10
  s_add_u32 m0, s39, 157696
  v_lshlrev_b32 v15, 4, v1
  buffer_load_dwordx4 v15, s[16:19], s39 offen sc1 lds
p0_nm:
  s_cmp_eq_u32 s55, -1
  s_cbranch_scc1 p0_n2
  s_add_u32 m0, s6, 0
  s_nop 0
  buffer_load_dwordx4 v13, s[8:11], s24 offen lds
  s_add_u32 m0, s6, 4096
  s_nop 0
  buffer_load_dwordx4 v13, s[12:15], s25 offen lds
  s_add_u32 s24, s24, s31
  s_add_u32 s25, s25, s31
  s_add_u32 m0, s6, 1024
  s_nop 0
  buffer_load_dwordx4 v13, s[8:11], s24 offen lds
  s_add_u32 m0, s6, 5120
  s_nop 0
  buffer_load_dwordx4 v13, s[12:15], s25 offen lds
  s_add_u32 s24, s24, s31
  s_add_u32 s25, s25, s31
  s_add_u32 m0, s6, 2048
  s_nop 0
  buffer_load_dwordx4 v13, s[8:11], s24 offen lds
  s_add_u32 m0, s6, 6144
  s_nop 0
  buffer_load_dwordx4 v13, s[12:15], s25 offen lds
  s_add_u32 s24, s24, s31
  s_add_u32 s25, s25, s31
  s_add_u32 m0, s6, 3072
  s_nop 0
  buffer_load_dwordx4 v13, s[8:11], s24 offen lds
  s_add_u32 m0, s6, 7168
  s_nop 0
  buffer_load_dwordx4 v13, s[12:15], s25 offen lds
  v_lshrrev_b32 v6, 1, v3
  s_sub_u32 s22, 3, s29
  v_lshlrev_b32 v6, s22, v6
  v_lshrrev_b32 v7, 2, v2
  v_add_u32 v6, v6, v7
  v_lshlrev_b32 v6, 8, v6
  v_and_b32 v7, 3, v2
  v_lshl_add_u32 v6, v7, 3, v6
  v_and_b32 v7, 1, v3
  s_cmp_eq_u32 s30, 1
  s_cselect_b32 s22, 12, 5
  v_lshl_add_u32 v6, v7, s22, v6
  v_add_u32 v6, s6, v6
  s_lshl_b32 s22, 0x400, s29
  v_add_u32 v7, s22, v6
  v_mov_b32 v12, v6
  v_mov_b32 v13, v7
  s_mov_b32 s52, s27
  s_mov_b32 s53, s28
  s_mov_b32 s54, s37
  s_mov_b32 s55, s30
p0_n2:
  ds_read_b64 v[16:17], v9 offset:0
  ds_read_b64 v[18:19], v9 offset:256
  ds_read_b64 v[20:21], v9 offset:2048
  ds_read_b64 v[22:23], v9 offset:2304
  s_waitcnt lgkmcnt(0)
  v_pk_add_f32 v[16:17], v[16:17], v[18:19]
  v_pk_add_f32 v[20:21], v[20:21], v[22:23]
  v_pk_add_f32 v[16:17], v[16:17], v[20:21]
  v_mul_f32 v16, 0x3b000000, v16
  v_mul_f32 v18, v16, v16
  v_mul_f32 v17, 0x3b000000, v17
  v_sub_f32 v17, v17, v18
  v_max_f32 v17, 0, v17
  v_cvt_pk_bf16_f32 v16, v16, v16
  v_and_b32 v16, 0xffff0000, v16
  v_cvt_pk_bf16_f32 v17, v17, v17
  v_and_b32 v17, 0xffff0000, v17
  v_add_f32 v17, 0x3727c5ac, v17
  v_cvt_pk_bf16_f32 v17, v17, v17
  v_and_b32 v17, 0xffff0000, v17
  v_sqrt_f32 v17, v17
  s_nop 0
  v_cvt_pk_bf16_f32 v17, v17, v17
  v_and_b32 v17, 0xffff0000, v17
  v_rcp_f32 v17, v17
  s_nop 0
  v_mul_f32 v16, v16, v17
  v_sub_f32 v16, 0, v16
  v_pk_fma_f32 v[128:129], v[128:129], v[16:17], v[16:17] op_sel:[0,1,0] op_sel_hi:[1,1,0]
  v_pk_fma_f32 v[130:131], v[130:131], v[16:17], v[16:17] op_sel:[0,1,0] op_sel_hi:[1,1,0]
  v_pk_fma_f32 v[132:133], v[132:133], v[16:17], v[16:17] op_sel:[0,1,0] op_sel_hi:[1,1,0]
  v_pk_fma_f32 v[134:135], v[134:135], v[16:17], v[16:17] op_sel:[0,1,0] op_sel_hi:[1,1,0]
  v_pk_fma_f32 v[136:137], v[136:137], v[16:17], v[16:17] op_sel:[0,1,0] op_sel_hi:[1,1,0]
  v_pk_fma_f32 v[138:139], v[138:139], v[16:17], v[16:17] op_sel:[0,1,0] op_sel_hi:[1,1,0]
  v_pk_fma_f32 v[140:141], v[140:141], v[16:17], v[16:17] op_sel:[0,1,0] op_sel_hi:[1,1,0]
  v_pk_fma_f32 v[142:143], v[142:143], v[16:17], v[16:17] op_sel:[0,1,0] op_sel_hi:[1,1,0]
  v_pk_fma_f32 v[144:145], v[144:145], v[16:17], v[16:17] op_sel:[0,1,0] op_sel_hi:[1,1,0]
  v_pk_fma_f32 v[146:147], v[146:147], v[16:17], v[16:17] op_sel:[0,1,0] op_sel_hi:[1,1,0]
  v_pk_fma_f32 v[148:149], v[148:149], v[16:17], v[16:17] op_sel:[0,1,0] op_sel_hi:[1,1,0]
  v_pk_fma_f32 v[150:151], v[150:151], v[16:17], v[16:17] op_sel:[0,1,0] op_sel_hi:[1,1,0]
  v_pk_fma_f32 v[152:153], v[152:153], v[16:17], v[16:17] op_sel:[0,1,0] op_sel_hi:[1,1,0]
  v_pk_fma_f32 v[154:155], v[154:155], v[16:17], v[16:17] op_sel:[0,1,0] op_sel_hi:[1,1,0]
  v_pk_fma_f32 v[156:157], v[156:157], v[16:17], v[16:17] op_sel:[0,1,0] op_sel_hi:[1,1,0]
  v_pk_fma_f32 v[158:159], v[158:159], v[16:17], v[16:17] op_sel:[0,1,0] op_sel_hi:[1,1,0]
  v_pk_fma_f32 v[160:161], v[160:161], v[16:17], v[16:17] op_sel:[0,1,0] op_sel_hi:[1,1,0]
  v_pk_fma_f32 v[162:163], v[162:163], v[16:17], v[16:17] op_sel:[0,1,0] op_sel_hi:[1,1,0]
  v_pk_fma_f32 v[164:165], v[164:165], v[16:17], v[16:17] op_sel:[0,1,0] op_sel_hi:[1,1,0]
  v_pk_fma_f32 v[166:167], v[166:167], v[16:17], v[16:17] op_sel:[0,1,0] op_sel_hi:[1,1,0]
  v_pk_fma_f32 v[168:169], v[168:169], v[16:17], v[16:17] op_sel:[0,1,0] op_sel_hi:[1,1,0]
  v_pk_fma_f32 v[170:171], v[170:171], v[16:17], v[16:17] op_sel:[0,1,0] op_sel_hi:[1,1,0]
  v_pk_fma_f32 v[172:173], v[172:173], v[16:17], v[16:17] op_sel:[0,1,0] op_sel_hi:[1,1,0]
  v_pk_fma_f32 v[174:175], v[174:175], v[16:17], v[16:17] op_sel:[0,1,0] op_sel_hi:[1,1,0]
  v_pk_fma_f32 v[176:177], v[176:177], v[16:17], v[16:17] op_sel:[0,1,0] op_sel_hi:[1,1,0]
  v_pk_fma_f32 v[178:179], v[178:179], v[16:17], v[16:17] op_sel:[0,1,0] op_sel_hi:[1,1,0]
  v_pk_fma_f32 v[180:181], v[180:181], v[16:17], v[16:17] op_sel:[0,1,0] op_sel_hi:[1,1,0]
  v_pk_fma_f32 v[182:183], v[182:183], v[16:17], v[16:17] op_sel:[0,1,0] op_sel_hi:[1,1,0]
  v_pk_fma_f32 v[184:185], v[184:185], v[16:17], v[16:17] op_sel:[0,1,0] op_sel_hi:[1,1,0]
  v_pk_fma_f32 v[186:187], v[186:187], v[16:17], v[16:17] op_sel:[0,1,0] op_sel_hi:[1,1,0]
  v_pk_fma_f32 v[188:189], v[188:189], v[16:17], v[16:17] op_sel:[0,1,0] op_sel_hi:[1,1,0]
  v_pk_fma_f32 v[190:191], v[190:191], v[16:17], v[16:17] op_sel:[0,1,0] op_sel_hi:[1,1,0]
  v_pk_fma_f32 v[192:193], v[192:193], v[16:17], v[16:17] op_sel:[0,1,0] op_sel_hi:[1,1,0]
  v_pk_fma_f32 v[194:195], v[194:195], v[16:17], v[16:17] op_sel:[0,1,0] op_sel_hi:[1,1,0]
  v_pk_fma_f32 v[196:197], v[196:197], v[16:17], v[16:17] op_sel:[0,1,0] op_sel_hi:[1,1,0]
  v_pk_fma_f32 v[198:199], v[198:199], v[16:17], v[16:17] op_sel:[0,1,0] op_sel_hi:[1,1,0]
  v_pk_fma_f32 v[200:201], v[200:201], v[16:17], v[16:17] op_sel:[0,1,0] op_sel_hi:[1,1,0]
  v_pk_fma_f32 v[202:203], v[202:203], v[16:17], v[16:17] op_sel:[0,1,0] op_sel_hi:[1,1,0]
  v_pk_fma_f32 v[204:205], v[204:205], v[16:17], v[16:17] op_sel:[0,1,0] op_sel_hi:[1,1,0]
  v_pk_fma_f32 v[206:207], v[206:207], v[16:17], v[16:17] op_sel:[0,1,0] op_sel_hi:[1,1,0]
  v_pk_fma_f32 v[208:209], v[208:209], v[16:17], v[16:17] op_sel:[0,1,0] op_sel_hi:[1,1,0]
  v_pk_fma_f32 v[210:211], v[210:211], v[16:17], v[16:17] op_sel:[0,1,0] op_sel_hi:[1,1,0]
  v_pk_fma_f32 v[212:213], v[212:213], v[16:17], v[16:17] op_sel:[0,1,0] op_sel_hi:[1,1,0]
  v_pk_fma_f32 v[214:215], v[214:215], v[16:17], v[16:17] op_sel:[0,1,0] op_sel_hi:[1,1,0]
  v_pk_fma_f32 v[216:217], v[216:217], v[16:17], v[16:17] op_sel:[0,1,0] op_sel_hi:[1,1,0]
  v_pk_fma_f32 v[218:219], v[218:219], v[16:17], v[16:17] op_sel:[0,1,0] op_sel_hi:[1,1,0]
  v_pk_fma_f32 v[220:221], v[220:221], v[16:17], v[16:17] op_sel:[0,1,0] op_sel_hi:[1,1,0]
  v_pk_fma_f32 v[222:223], v[222:223], v[16:17], v[16:17] op_sel:[0,1,0] op_sel_hi:[1,1,0]
  v_pk_fma_f32 v[224:225], v[224:225], v[16:17], v[16:17] op_sel:[0,1,0] op_sel_hi:[1,1,0]
  v_pk_fma_f32 v[226:227], v[226:227], v[16:17], v[16:17] op_sel:[0,1,0] op_sel_hi:[1,1,0]
  v_pk_fma_f32 v[228:229], v[228:229], v[16:17], v[16:17] op_sel:[0,1,0] op_sel_hi:[1,1,0]
  v_pk_fma_f32 v[230:231], v[230:231], v[16:17], v[16:17] op_sel:[0,1,0] op_sel_hi:[1,1,0]
  v_pk_fma_f32 v[232:233], v[232:233], v[16:17], v[16:17] op_sel:[0,1,0] op_sel_hi:[1,1,0]
  v_pk_fma_f32 v[234:235], v[234:235], v[16:17], v[16:17] op_sel:[0,1,0] op_sel_hi:[1,1,0]
  v_pk_fma_f32 v[236:237], v[236:237], v[16:17], v[16:17] op_sel:[0,1,0] op_sel_hi:[1,1,0]
  v_pk_fma_f32 v[238:239], v[238:239], v[16:17], v[16:17] op_sel:[0,1,0] op_sel_hi:[1,1,0]
  v_pk_fma_f32 v[240:241], v[240:241], v[16:17], v[16:17] op_sel:[0,1,0] op_sel_hi:[1,1,0]
  v_pk_fma_f32 v[242:243], v[242:243], v[16:17], v[16:17] op_sel:[0,1,0] op_sel_hi:[1,1,0]
  v_pk_fma_f32 v[244:245], v[244:245], v[16:17], v[16:17] op_sel:[0,1,0] op_sel_hi:[1,1,0]
  v_pk_fma_f32 v[246:247], v[246:247], v[16:17], v[16:17] op_sel:[0,1,0] op_sel_hi:[1,1,0]
  v_pk_fma_f32 v[248:249], v[248:249], v[16:17], v[16:17] op_sel:[0,1,0] op_sel_hi:[1,1,0]
  v_pk_fma_f32 v[250:251], v[250:251], v[16:17], v[16:17] op_sel:[0,1,0] op_sel_hi:[1,1,0]
  v_pk_fma_f32 v[252:253], v[252:253], v[16:17], v[16:17] op_sel:[0,1,0] op_sel_hi:[1,1,0]
  v_pk_fma_f32 v[254:255], v[254:255], v[16:17], v[16:17] op_sel:[0,1,0] op_sel_hi:[1,1,0]
  s_load_dwordx2 s[12:13], s[0:1], 88
  s_load_dwordx2 s[16:17], s[0:1], 0
  s_load_dwordx2 s[20:21], s[0:1], 72
  s_mov_b32 s14, 31457280
  s_mov_b32 s15, 0x20000
  s_mov_b32 s18, 2097152
  s_mov_b32 s19, 0x20000
  s_mov_b32 s22, 2097152
  s_mov_b32 s23, 0x20000
  v_and_b32 v1, 63, v0
  v_lshrrev_b32 v4, 6, v0
  v_lshlrev_b32 v2, 4, v1
  v_readfirstlane_b32 s4, v4
  v_and_b32 v3, 31, v0
  v_bfe_u32 v4, v0, 5, 1
  s_and_b32 s7, s4, 3
  s_and_b32 s27, s2, 1
  s_lshl_b32 s8, s27, 3
  s_bfe_u32 s27, s2, 196611
  s_add_u32 s8, s8, s27
  s_bfe_u32 s27, s2, 131073
  s_lshl_b32 s9, s27, 2
  s_lshr_b32 s27, s2, 6
  s_add_u32 s9, s9, s27
  s_and_b32 s27, s2, 7
  s_lshl_b32 s10, s27, 2
  s_bfe_u32 s27, s2, 131075
  s_add_u32 s10, s10, s27
  s_bfe_u32 s27, s2, 3
  s_lshl_b32 s11, s27, 3
  s_lshr_b32 s27, s2, 5
  s_add_u32 s11, s11, s27
  s_and_b32 s27, s2, 1
  s_lshl_b32 s44, s27, 3
  s_bfe_u32 s27, s2, 196611
  s_add_u32 s44, s44, s27
  s_bfe_u32 s27, s2, 131073
  s_lshl_b32 s45, s27, 2
  s_lshr_b32 s27, s2, 6
  s_add_u32 s45, s45, s27
  s_lshl_b32 s46, s44, 2
  s_add_u32 s46, s46, s7
  s_lshl_b32 s47, s44, 4
  s_add_u32 s47, s47, s45
  s_lshl_b32 s47, s47, 7
  s_lshl_b32 s24, s8, 2
  s_add_u32 s24, s24, s7
  s_lshl_b32 s25, s10, 1
  s_and_b32 s27, s4, 1
  s_add_u32 s25, s25, s27
  s_lshr_b32 s26, s4, 1
  s_lshl_b32 s5, s8, 4
  s_add_u32 s5, s5, s9
  s_lshl_b32 s5, s5, 7
  s_lshl_b32 s6, s10, 3
  s_add_u32 s6, s6, s11
  s_lshl_b32 s6, s6, 7
  s_lshr_b32 s51, s10, 1
  s_lshr_b32 s34, s6, 8
  s_bitcmp1_b32 s6, 7
  s_cselect_b32 s34, 127, s34
  s_lshl_b32 s40, s11, 16
  s_lshl_b32 s27, s26, 14
  s_add_u32 s40, s40, s27
  s_add_u32 s40, s40, 1835008
  s_mul_i32 s41, s45, 229376
  s_add_u32 s41, s41, 2359296
  s_mul_i32 s42, s11, 229376
  s_mul_i32 s27, s4, 28672
  s_add_u32 s42, s42, s27
  s_add_u32 s42, s42, 6029312
  v_add_u32 v14, 0x10000, v2
  v_add_u32 v15, 0x20000, v2
  s_waitcnt lgkmcnt(0)
  s_lshr_b32 s37, s4, 2
  v_bfe_u32 v8, v1, 2, 2
  v_lshl_add_u32 v8, v4, 3, v8
  v_lshlrev_b32 v8, 6, v8
  v_bfe_u32 v9, v1, 4, 1
  v_lshl_add_u32 v8, v9, 5, v8
  v_and_b32 v9, 3, v1
  v_lshl_add_u32 v8, v9, 3, v8
  s_lshl_b32 s27, s37, 14
  v_add_u32 v8, s27, v8
  v_add_u32 v9, 0x10000, v8
  v_lshlrev_b32 v7, 5, v4
  s_lshl_b32 s27, s37, 10
  s_add_u32 s27, s27, 157696
  v_add_u32 v7, s27, v7
  s_cmp_lg_u32 s55, -1
  s_cbranch_scc1 p1_w8
  s_waitcnt vmcnt(0)
p1_w8:
  s_waitcnt vmcnt(8)
  s_barrier
  ds_read_b128 v[88:91], v7 offset:0
  ds_read_b128 v[92:95], v7 offset:16
  ds_read_b128 v[96:99], v7 offset:2048
  ds_read_b128 v[100:103], v7 offset:2064
  ds_read_b128 v[104:107], v7 offset:64
  ds_read_b128 v[108:111], v7 offset:80
  ds_read_b128 v[112:115], v7 offset:2112
  ds_read_b128 v[116:119], v7 offset:2128
  ds_read_b64_tr_b16 v[64:65], v8 offset:32768
  ds_read_b64_tr_b16 v[66:67], v8 offset:33024
  ds_read_b64_tr_b16 v[68:69], v9 offset:0
  ds_read_b64_tr_b16 v[70:71], v9 offset:256
  ds_read_b64_tr_b16 v[72:73], v8 offset:0
  ds_read_b64_tr_b16 v[74:75], v8 offset:256
  s_waitcnt lgkmcnt(10)
  v_pk_fma_f32 v[128:129], v[128:129], v[96:97], v[88:89]
  v_pk_fma_f32 v[130:131], v[130:131], v[98:99], v[90:91]
  v_pk_fma_f32 v[132:133], v[132:133], v[100:101], v[92:93]
  v_pk_fma_f32 v[134:135], v[134:135], v[102:103], v[94:95]
  ds_read_b128 v[88:91], v7 offset:128
  ds_read_b128 v[92:95], v7 offset:144
  ds_read_b128 v[96:99], v7 offset:2176
  ds_read_b128 v[100:103], v7 offset:2192
  v_cvt_pk_bf16_f32 v120, v128, v129
  v_cvt_pk_bf16_f32 v121, v130, v131
  v_cvt_pk_bf16_f32 v122, v132, v133
  v_cvt_pk_bf16_f32 v123, v134, v135
  ds_read_b64_tr_b16 v[76:77], v8 offset:33792
  ds_read_b64_tr_b16 v[78:79], v8 offset:34048
  s_waitcnt lgkmcnt(10)
  v_mfma_f32_32x32x16_bf16 v[16:31], v[64:67], v[120:123], 0
  v_pk_fma_f32 v[136:137], v[136:137], v[112:113], v[104:105]
  v_pk_fma_f32 v[138:139], v[138:139], v[114:115], v[106:107]
  v_pk_fma_f32 v[140:141], v[140:141], v[116:117], v[108:109]
  v_pk_fma_f32 v[142:143], v[142:143], v[118:119], v[110:111]
  ds_read_b128 v[104:107], v7 offset:192
  ds_read_b128 v[108:111], v7 offset:208
  ds_read_b128 v[112:115], v7 offset:2240
  ds_read_b128 v[116:119], v7 offset:2256
  v_cvt_pk_bf16_f32 v124, v136, v137
  v_cvt_pk_bf16_f32 v125, v138, v139
  v_cvt_pk_bf16_f32 v126, v140, v141
  v_cvt_pk_bf16_f32 v127, v142, v143
  ds_read_b64_tr_b16 v[80:81], v9 offset:1024
  ds_read_b64_tr_b16 v[82:83], v9 offset:1280
  s_waitcnt lgkmcnt(14)
  v_mfma_f32_32x32x16_bf16 v[32:47], v[120:123], v[68:71], 0
  ds_read_b64_tr_b16 v[84:85], v8 offset:1024
  ds_read_b64_tr_b16 v[86:87], v8 offset:1280
  s_waitcnt lgkmcnt(14)
  v_mfma_f32_32x32x16_bf16 v[48:63], v[72:75], v[120:123], 0
  ds_read_b64_tr_b16 v[64:65], v8 offset:34816
  ds_read_b64_tr_b16 v[66:67], v8 offset:35072
  s_waitcnt lgkmcnt(10)
  v_mfma_f32_32x32x16_bf16 v[16:31], v[76:79], v[124:127], v[16:31]
  v_pk_fma_f32 v[144:145], v[144:145], v[96:97], v[88:89]
  v_pk_fma_f32 v[146:147], v[146:147], v[98:99], v[90:91]
  v_pk_fma_f32 v[148:149], v[148:149], v[100:101], v[92:93]
  v_pk_fma_f32 v[150:151], v[150:151], v[102:103], v[94:95]
  ds_read_b128 v[88:91], v7 offset:256
  ds_read_b128 v[92:95], v7 offset:272
  ds_read_b128 v[96:99], v7 offset:2304
  ds_read_b128 v[100:103], v7 offset:2320
  v_cvt_pk_bf16_f32 v120, v144, v145
  v_cvt_pk_bf16_f32 v121, v146, v147
  v_cvt_pk_bf16_f32 v122, v148, v149
  v_cvt_pk_bf16_f32 v123, v150, v151
  ds_read_b64_tr_b16 v[68:69], v9 offset:2048
  ds_read_b64_tr_b16 v[70:71], v9 offset:2304
  s_waitcnt lgkmcnt(10)
  v_mfma_f32_32x32x16_bf16 v[32:47], v[124:127], v[80:83], v[32:47]
  ds_read_b64_tr_b16 v[72:73], v8 offset:2048
  ds_read_b64_tr_b16 v[74:75], v8 offset:2304
  s_waitcnt lgkmcnt(10)
  v_mfma_f32_32x32x16_bf16 v[48:63], v[84:87], v[124:127], v[48:63]
  ds_read_b64_tr_b16 v[76:77], v8 offset:35840
  ds_read_b64_tr_b16 v[78:79], v8 offset:36096
  s_waitcnt lgkmcnt(10)
  v_mfma_f32_32x32x16_bf16 v[16:31], v[64:67], v[120:123], v[16:31]
  v_pk_fma_f32 v[152:153], v[152:153], v[112:113], v[104:105]
  v_pk_fma_f32 v[154:155], v[154:155], v[114:115], v[106:107]
  v_pk_fma_f32 v[156:157], v[156:157], v[116:117], v[108:109]
  v_pk_fma_f32 v[158:159], v[158:159], v[118:119], v[110:111]
  ds_read_b128 v[104:107], v7 offset:320
  ds_read_b128 v[108:111], v7 offset:336
  ds_read_b128 v[112:115], v7 offset:2368
  ds_read_b128 v[116:119], v7 offset:2384
  v_cvt_pk_bf16_f32 v124, v152, v153
  v_cvt_pk_bf16_f32 v125, v154, v155
  v_cvt_pk_bf16_f32 v126, v156, v157
  v_cvt_pk_bf16_f32 v127, v158, v159
  ds_read_b64_tr_b16 v[80:81], v9 offset:3072
  ds_read_b64_tr_b16 v[82:83], v9 offset:3328
  s_waitcnt lgkmcnt(10)
  v_mfma_f32_32x32x16_bf16 v[32:47], v[120:123], v[68:71], v[32:47]
  ds_read_b64_tr_b16 v[84:85], v8 offset:3072
  ds_read_b64_tr_b16 v[86:87], v8 offset:3328
  s_waitcnt lgkmcnt(10)
  v_mfma_f32_32x32x16_bf16 v[48:63], v[72:75], v[120:123], v[48:63]
  ds_read_b64_tr_b16 v[64:65], v8 offset:36864
  ds_read_b64_tr_b16 v[66:67], v8 offset:37120
  s_waitcnt lgkmcnt(10)
  v_mfma_f32_32x32x16_bf16 v[16:31], v[76:79], v[124:127], v[16:31]
  v_pk_fma_f32 v[160:161], v[160:161], v[96:97], v[88:89]
  v_pk_fma_f32 v[162:163], v[162:163], v[98:99], v[90:91]
  v_pk_fma_f32 v[164:165], v[164:165], v[100:101], v[92:93]
  v_pk_fma_f32 v[166:167], v[166:167], v[102:103], v[94:95]
  ds_read_b128 v[88:91], v7 offset:384
  ds_read_b128 v[92:95], v7 offset:400
  ds_read_b128 v[96:99], v7 offset:2432
  ds_read_b128 v[100:103], v7 offset:2448
  v_cvt_pk_bf16_f32 v120, v160, v161
  v_cvt_pk_bf16_f32 v121, v162, v163
  v_cvt_pk_bf16_f32 v122, v164, v165
  v_cvt_pk_bf16_f32 v123, v166, v167
  ds_read_b64_tr_b16 v[68:69], v9 offset:4096
  ds_read_b64_tr_b16 v[70:71], v9 offset:4352
  s_waitcnt lgkmcnt(10)
  v_mfma_f32_32x32x16_bf16 v[32:47], v[124:127], v[80:83], v[32:47]
  ds_read_b64_tr_b16 v[72:73], v8 offset:4096
  ds_read_b64_tr_b16 v[74:75], v8 offset:4352
  s_waitcnt lgkmcnt(10)
  v_mfma_f32_32x32x16_bf16 v[48:63], v[84:87], v[124:127], v[48:63]
  ds_read_b64_tr_b16 v[76:77], v8 offset:37888
  ds_read_b64_tr_b16 v[78:79], v8 offset:38144
  s_waitcnt lgkmcnt(10)
  v_mfma_f32_32x32x16_bf16 v[16:31], v[64:67], v[120:123], v[16:31]
  v_pk_fma_f32 v[168:169], v[168:169], v[112:113], v[104:105]
  v_pk_fma_f32 v[170:171], v[170:171], v[114:115], v[106:107]
  v_pk_fma_f32 v[172:173], v[172:173], v[116:117], v[108:109]
  v_pk_fma_f32 v[174:175], v[174:175], v[118:119], v[110:111]
  ds_read_b128 v[104:107], v7 offset:448
  ds_read_b128 v[108:111], v7 offset:464
  ds_read_b128 v[112:115], v7 offset:2496
  ds_read_b128 v[116:119], v7 offset:2512
  v_cvt_pk_bf16_f32 v124, v168, v169
  v_cvt_pk_bf16_f32 v125, v170, v171
  v_cvt_pk_bf16_f32 v126, v172, v173
  v_cvt_pk_bf16_f32 v127, v174, v175
  ds_read_b64_tr_b16 v[80:81], v9 offset:5120
  ds_read_b64_tr_b16 v[82:83], v9 offset:5376
  s_waitcnt lgkmcnt(10)
  v_mfma_f32_32x32x16_bf16 v[32:47], v[120:123], v[68:71], v[32:47]
  ds_read_b64_tr_b16 v[84:85], v8 offset:5120
  ds_read_b64_tr_b16 v[86:87], v8 offset:5376
  s_waitcnt lgkmcnt(10)
  v_mfma_f32_32x32x16_bf16 v[48:63], v[72:75], v[120:123], v[48:63]
  ds_read_b64_tr_b16 v[64:65], v8 offset:38912
  ds_read_b64_tr_b16 v[66:67], v8 offset:39168
  s_waitcnt lgkmcnt(10)
  v_mfma_f32_32x32x16_bf16 v[16:31], v[76:79], v[124:127], v[16:31]
  v_pk_fma_f32 v[176:177], v[176:177], v[96:97], v[88:89]
  v_pk_fma_f32 v[178:179], v[178:179], v[98:99], v[90:91]
  v_pk_fma_f32 v[180:181], v[180:181], v[100:101], v[92:93]
  v_pk_fma_f32 v[182:183], v[182:183], v[102:103], v[94:95]
  ds_read_b128 v[88:91], v7 offset:512
  ds_read_b128 v[92:95], v7 offset:528
  ds_read_b128 v[96:99], v7 offset:2560
  ds_read_b128 v[100:103], v7 offset:2576
  v_cvt_pk_bf16_f32 v120, v176, v177
  v_cvt_pk_bf16_f32 v121, v178, v179
  v_cvt_pk_bf16_f32 v122, v180, v181
  v_cvt_pk_bf16_f32 v123, v182, v183
  ds_read_b64_tr_b16 v[68:69], v9 offset:6144
  ds_read_b64_tr_b16 v[70:71], v9 offset:6400
  s_waitcnt lgkmcnt(10)
  v_mfma_f32_32x32x16_bf16 v[32:47], v[124:127], v[80:83], v[32:47]
  ds_read_b64_tr_b16 v[72:73], v8 offset:6144
  ds_read_b64_tr_b16 v[74:75], v8 offset:6400
  s_waitcnt lgkmcnt(10)
  v_mfma_f32_32x32x16_bf16 v[48:63], v[84:87], v[124:127], v[48:63]
  ds_read_b64_tr_b16 v[76:77], v8 offset:39936
  ds_read_b64_tr_b16 v[78:79], v8 offset:40192
  s_waitcnt lgkmcnt(10)
  v_mfma_f32_32x32x16_bf16 v[16:31], v[64:67], v[120:123], v[16:31]
  v_pk_fma_f32 v[184:185], v[184:185], v[112:113], v[104:105]
  v_pk_fma_f32 v[186:187], v[186:187], v[114:115], v[106:107]
  v_pk_fma_f32 v[188:189], v[188:189], v[116:117], v[108:109]
  v_pk_fma_f32 v[190:191], v[190:191], v[118:119], v[110:111]
  ds_read_b128 v[104:107], v7 offset:576
  ds_read_b128 v[108:111], v7 offset:592
  ds_read_b128 v[112:115], v7 offset:2624
  ds_read_b128 v[116:119], v7 offset:2640
  v_cvt_pk_bf16_f32 v124, v184, v185
  v_cvt_pk_bf16_f32 v125, v186, v187
  v_cvt_pk_bf16_f32 v126, v188, v189
  v_cvt_pk_bf16_f32 v127, v190, v191
  ds_read_b64_tr_b16 v[80:81], v9 offset:7168
  ds_read_b64_tr_b16 v[82:83], v9 offset:7424
  s_waitcnt lgkmcnt(10)
  v_mfma_f32_32x32x16_bf16 v[32:47], v[120:123], v[68:71], v[32:47]
  ds_read_b64_tr_b16 v[84:85], v8 offset:7168
  ds_read_b64_tr_b16 v[86:87], v8 offset:7424
  s_waitcnt lgkmcnt(10)
  v_mfma_f32_32x32x16_bf16 v[48:63], v[72:75], v[120:123], v[48:63]
  ds_read_b64_tr_b16 v[64:65], v8 offset:40960
  ds_read_b64_tr_b16 v[66:67], v8 offset:41216
  s_waitcnt lgkmcnt(10)
  v_mfma_f32_32x32x16_bf16 v[16:31], v[76:79], v[124:127], v[16:31]
  v_pk_fma_f32 v[192:193], v[192:193], v[96:97], v[88:89]
  v_pk_fma_f32 v[194:195], v[194:195], v[98:99], v[90:91]
  v_pk_fma_f32 v[196:197], v[196:197], v[100:101], v[92:93]
  v_pk_fma_f32 v[198:199], v[198:199], v[102:103], v[94:95]
  ds_read_b128 v[88:91], v7 offset:640
  ds_read_b128 v[92:95], v7 offset:656
  ds_read_b128 v[96:99], v7 offset:2688
  ds_read_b128 v[100:103], v7 offset:2704
  v_cvt_pk_bf16_f32 v120, v192, v193
  v_cvt_pk_bf16_f32 v121, v194, v195
  v_cvt_pk_bf16_f32 v122, v196, v197
  v_cvt_pk_bf16_f32 v123, v198, v199
  ds_read_b64_tr_b16 v[68:69], v9 offset:8192
  ds_read_b64_tr_b16 v[70:71], v9 offset:8448
  s_waitcnt lgkmcnt(10)
  v_mfma_f32_32x32x16_bf16 v[32:47], v[124:127], v[80:83], v[32:47]
  ds_read_b64_tr_b16 v[72:73], v8 offset:8192
  ds_read_b64_tr_b16 v[74:75], v8 offset:8448
  s_waitcnt lgkmcnt(10)
  v_mfma_f32_32x32x16_bf16 v[48:63], v[84:87], v[124:127], v[48:63]
  ds_read_b64_tr_b16 v[76:77], v8 offset:41984
  ds_read_b64_tr_b16 v[78:79], v8 offset:42240
  s_waitcnt lgkmcnt(10)
  v_mfma_f32_32x32x16_bf16 v[16:31], v[64:67], v[120:123], v[16:31]
  v_pk_fma_f32 v[200:201], v[200:201], v[112:113], v[104:105]
  v_pk_fma_f32 v[202:203], v[202:203], v[114:115], v[106:107]
  v_pk_fma_f32 v[204:205], v[204:205], v[116:117], v[108:109]
  v_pk_fma_f32 v[206:207], v[206:207], v[118:119], v[110:111]
  ds_read_b128 v[104:107], v7 offset:704
  ds_read_b128 v[108:111], v7 offset:720
  ds_read_b128 v[112:115], v7 offset:2752
  ds_read_b128 v[116:119], v7 offset:2768
  v_cvt_pk_bf16_f32 v124, v200, v201
  v_cvt_pk_bf16_f32 v125, v202, v203
  v_cvt_pk_bf16_f32 v126, v204, v205
  v_cvt_pk_bf16_f32 v127, v206, v207
  ds_read_b64_tr_b16 v[80:81], v9 offset:9216
  ds_read_b64_tr_b16 v[82:83], v9 offset:9472
  s_waitcnt lgkmcnt(10)
  v_mfma_f32_32x32x16_bf16 v[32:47], v[120:123], v[68:71], v[32:47]
  ds_read_b64_tr_b16 v[84:85], v8 offset:9216
  ds_read_b64_tr_b16 v[86:87], v8 offset:9472
  s_waitcnt lgkmcnt(10)
  v_mfma_f32_32x32x16_bf16 v[48:63], v[72:75], v[120:123], v[48:63]
  ds_read_b64_tr_b16 v[64:65], v8 offset:43008
  ds_read_b64_tr_b16 v[66:67], v8 offset:43264
  s_waitcnt lgkmcnt(10)
  v_mfma_f32_32x32x16_bf16 v[16:31], v[76:79], v[124:127], v[16:31]
  v_pk_fma_f32 v[208:209], v[208:209], v[96:97], v[88:89]
  v_pk_fma_f32 v[210:211], v[210:211], v[98:99], v[90:91]
  v_pk_fma_f32 v[212:213], v[212:213], v[100:101], v[92:93]
  v_pk_fma_f32 v[214:215], v[214:215], v[102:103], v[94:95]
  ds_read_b128 v[88:91], v7 offset:768
  ds_read_b128 v[92:95], v7 offset:784
  ds_read_b128 v[96:99], v7 offset:2816
  ds_read_b128 v[100:103], v7 offset:2832
  v_cvt_pk_bf16_f32 v120, v208, v209
  v_cvt_pk_bf16_f32 v121, v210, v211
  v_cvt_pk_bf16_f32 v122, v212, v213
  v_cvt_pk_bf16_f32 v123, v214, v215
  ds_read_b64_tr_b16 v[68:69], v9 offset:10240
  ds_read_b64_tr_b16 v[70:71], v9 offset:10496
  s_waitcnt lgkmcnt(10)
  v_mfma_f32_32x32x16_bf16 v[32:47], v[124:127], v[80:83], v[32:47]
  ds_read_b64_tr_b16 v[72:73], v8 offset:10240
  ds_read_b64_tr_b16 v[74:75], v8 offset:10496
  s_waitcnt lgkmcnt(10)
  v_mfma_f32_32x32x16_bf16 v[48:63], v[84:87], v[124:127], v[48:63]
  ds_read_b64_tr_b16 v[76:77], v8 offset:44032
  ds_read_b64_tr_b16 v[78:79], v8 offset:44288
  s_waitcnt lgkmcnt(10)
  v_mfma_f32_32x32x16_bf16 v[16:31], v[64:67], v[120:123], v[16:31]
  v_pk_fma_f32 v[216:217], v[216:217], v[112:113], v[104:105]
  v_pk_fma_f32 v[218:219], v[218:219], v[114:115], v[106:107]
  v_pk_fma_f32 v[220:221], v[220:221], v[116:117], v[108:109]
  v_pk_fma_f32 v[222:223], v[222:223], v[118:119], v[110:111]
  ds_read_b128 v[104:107], v7 offset:832
  ds_read_b128 v[108:111], v7 offset:848
  ds_read_b128 v[112:115], v7 offset:2880
  ds_read_b128 v[116:119], v7 offset:2896
  v_cvt_pk_bf16_f32 v124, v216, v217
  v_cvt_pk_bf16_f32 v125, v218, v219
  v_cvt_pk_bf16_f32 v126, v220, v221
  v_cvt_pk_bf16_f32 v127, v222, v223
  ds_read_b64_tr_b16 v[80:81], v9 offset:11264
  ds_read_b64_tr_b16 v[82:83], v9 offset:11520
  s_waitcnt lgkmcnt(10)
  v_mfma_f32_32x32x16_bf16 v[32:47], v[120:123], v[68:71], v[32:47]
  ds_read_b64_tr_b16 v[84:85], v8 offset:11264
  ds_read_b64_tr_b16 v[86:87], v8 offset:11520
  s_waitcnt lgkmcnt(10)
  v_mfma_f32_32x32x16_bf16 v[48:63], v[72:75], v[120:123], v[48:63]
  ds_read_b64_tr_b16 v[64:65], v8 offset:45056
  ds_read_b64_tr_b16 v[66:67], v8 offset:45312
  s_waitcnt lgkmcnt(10)
  v_mfma_f32_32x32x16_bf16 v[16:31], v[76:79], v[124:127], v[16:31]
  v_pk_fma_f32 v[224:225], v[224:225], v[96:97], v[88:89]
  v_pk_fma_f32 v[226:227], v[226:227], v[98:99], v[90:91]
  v_pk_fma_f32 v[228:229], v[228:229], v[100:101], v[92:93]
  v_pk_fma_f32 v[230:231], v[230:231], v[102:103], v[94:95]
  ds_read_b128 v[88:91], v7 offset:896
  ds_read_b128 v[92:95], v7 offset:912
  ds_read_b128 v[96:99], v7 offset:2944
  ds_read_b128 v[100:103], v7 offset:2960
  v_cvt_pk_bf16_f32 v120, v224, v225
  v_cvt_pk_bf16_f32 v121, v226, v227
  v_cvt_pk_bf16_f32 v122, v228, v229
  v_cvt_pk_bf16_f32 v123, v230, v231
  ds_read_b64_tr_b16 v[68:69], v9 offset:12288
  ds_read_b64_tr_b16 v[70:71], v9 offset:12544
  s_waitcnt lgkmcnt(10)
  v_mfma_f32_32x32x16_bf16 v[32:47], v[124:127], v[80:83], v[32:47]
  ds_read_b64_tr_b16 v[72:73], v8 offset:12288
  ds_read_b64_tr_b16 v[74:75], v8 offset:12544
  s_waitcnt lgkmcnt(10)
  v_mfma_f32_32x32x16_bf16 v[48:63], v[84:87], v[124:127], v[48:63]
  s_cmp_eq_u32 s55, -1
  s_cbranch_scc1 p1_nj
  s_waitcnt vmcnt(0)
  s_cmp_eq_u32 s55, 1
  s_cbranch_scc1 pa_tg
  ds_read_b64_tr_b16 v[128:129], v12 offset:0
  ds_read_b64_tr_b16 v[130:131], v13 offset:0
  ds_read_b64_tr_b16 v[132:133], v12 offset:64
  ds_read_b64_tr_b16 v[134:135], v13 offset:64
  ds_read_b64_tr_b16 v[136:137], v12 offset:128
  ds_read_b64_tr_b16 v[138:139], v13 offset:128
  ds_read_b64_tr_b16 v[140:141], v12 offset:192
  ds_read_b64_tr_b16 v[142:143], v13 offset:192
  ds_read_b64_tr_b16 v[144:145], v12 offset:4096
  ds_read_b64_tr_b16 v[146:147], v13 offset:4096
  ds_read_b64_tr_b16 v[148:149], v12 offset:4160
  ds_read_b64_tr_b16 v[150:151], v13 offset:4160
  ds_read_b64_tr_b16 v[152:153], v12 offset:4224
  ds_read_b64_tr_b16 v[154:155], v13 offset:4224
  ds_read_b64_tr_b16 v[156:157], v12 offset:4288
  ds_read_b64_tr_b16 v[158:159], v13 offset:4288
  s_branch pa_tj
pa_tg:
  ds_read_b64_tr_b16 v[128:129], v12 offset:0
  ds_read_b64_tr_b16 v[130:131], v13 offset:0
  ds_read_b64_tr_b16 v[132:133], v12 offset:32
  ds_read_b64_tr_b16 v[134:135], v13 offset:32
  ds_read_b64_tr_b16 v[136:137], v12 offset:64
  ds_read_b64_tr_b16 v[138:139], v13 offset:64
  ds_read_b64_tr_b16 v[140:141], v12 offset:96
  ds_read_b64_tr_b16 v[142:143], v13 offset:96
  ds_read_b64_tr_b16 v[144:145], v12 offset:128
  ds_read_b64_tr_b16 v[146:147], v13 offset:128
  ds_read_b64_tr_b16 v[148:149], v12 offset:160
  ds_read_b64_tr_b16 v[150:151], v13 offset:160
  ds_read_b64_tr_b16 v[152:153], v12 offset:192
  ds_read_b64_tr_b16 v[154:155], v13 offset:192
  ds_read_b64_tr_b16 v[156:157], v12 offset:224
  ds_read_b64_tr_b16 v[158:159], v13 offset:224
pa_tj:
  s_waitcnt lgkmcnt(0)
  buffer_store_dwordx4 v[128:131], v2, s[12:15], s52 offen sc1
  s_add_u32 s27, s52, s54
  s_add_u32 s52, s52, s53
  buffer_store_dwordx4 v[132:135], v2, s[12:15], s27 offen sc1
  buffer_store_dwordx4 v[136:139], v2, s[12:15], s52 offen sc1
  s_add_u32 s27, s52, s54
  s_add_u32 s52, s52, s53
  buffer_store_dwordx4 v[140:143], v2, s[12:15], s27 offen sc1
  buffer_store_dwordx4 v[144:147], v2, s[12:15], s52 offen sc1
  s_add_u32 s27, s52, s54
  s_add_u32 s52, s52, s53
  buffer_store_dwordx4 v[148:151], v2, s[12:15], s27 offen sc1
  buffer_store_dwordx4 v[152:155], v2, s[12:15], s52 offen sc1
  s_add_u32 s27, s52, s54
  s_add_u32 s52, s52, s53
  buffer_store_dwordx4 v[156:159], v2, s[12:15], s27 offen sc1
p1_nj:
  ds_read_b64_tr_b16 v[76:77], v8 offset:46080
  ds_read_b64_tr_b16 v[78:79], v8 offset:46336
  s_waitcnt lgkmcnt(10)
  v_mfma_f32_32x32x16_bf16 v[16:31], v[64:67], v[120:123], v[16:31]
  v_pk_fma_f32 v[232:233], v[232:233], v[112:113], v[104:105]
  v_pk_fma_f32 v[234:235], v[234:235], v[114:115], v[106:107]
  v_pk_fma_f32 v[236:237], v[236:237], v[116:117], v[108:109]
  v_pk_fma_f32 v[238:239], v[238:239], v[118:119], v[110:111]
  ds_read_b128 v[104:107], v7 offset:960
  ds_read_b128 v[108:111], v7 offset:976
  ds_read_b128 v[112:115], v7 offset:3008
  ds_read_b128 v[116:119], v7 offset:3024
  v_cvt_pk_bf16_f32 v124, v232, v233
  v_cvt_pk_bf16_f32 v125, v234, v235
  v_cvt_pk_bf16_f32 v126, v236, v237
  v_cvt_pk_bf16_f32 v127, v238, v239
  ds_read_b64_tr_b16 v[80:81], v9 offset:13312
  ds_read_b64_tr_b16 v[82:83], v9 offset:13568
  s_waitcnt lgkmcnt(10)
  v_mfma_f32_32x32x16_bf16 v[32:47], v[120:123], v[68:71], v[32:47]
  ds_read_b64_tr_b16 v[84:85], v8 offset:13312
  ds_read_b64_tr_b16 v[86:87], v8 offset:13568
  s_waitcnt lgkmcnt(10)
  v_mfma_f32_32x32x16_bf16 v[48:63], v[72:75], v[120:123], v[48:63]
  ds_read_b64_tr_b16 v[64:65], v8 offset:47104
  ds_read_b64_tr_b16 v[66:67], v8 offset:47360
  s_waitcnt lgkmcnt(10)
  v_mfma_f32_32x32x16_bf16 v[16:31], v[76:79], v[124:127], v[16:31]
  v_pk_fma_f32 v[240:241], v[240:241], v[96:97], v[88:89]
  v_pk_fma_f32 v[242:243], v[242:243], v[98:99], v[90:91]
  v_pk_fma_f32 v[244:245], v[244:245], v[100:101], v[92:93]
  v_pk_fma_f32 v[246:247], v[246:247], v[102:103], v[94:95]
  v_cvt_pk_bf16_f32 v120, v240, v241
  v_cvt_pk_bf16_f32 v121, v242, v243
  v_cvt_pk_bf16_f32 v122, v244, v245
  v_cvt_pk_bf16_f32 v123, v246, v247
  ds_read_b64_tr_b16 v[68:69], v9 offset:14336
  ds_read_b64_tr_b16 v[70:71], v9 offset:14592
  s_waitcnt lgkmcnt(6)
  v_mfma_f32_32x32x16_bf16 v[32:47], v[124:127], v[80:83], v[32:47]
  ds_read_b64_tr_b16 v[72:73], v8 offset:14336
  ds_read_b64_tr_b16 v[74:75], v8 offset:14592
  s_waitcnt lgkmcnt(6)
  v_mfma_f32_32x32x16_bf16 v[48:63], v[84:87], v[124:127], v[48:63]
  ds_read_b64_tr_b16 v[76:77], v8 offset:48128
  ds_read_b64_tr_b16 v[78:79], v8 offset:48384
  s_waitcnt lgkmcnt(6)
  v_mfma_f32_32x32x16_bf16 v[16:31], v[64:67], v[120:123], v[16:31]
  v_pk_fma_f32 v[248:249], v[248:249], v[112:113], v[104:105]
  v_pk_fma_f32 v[250:251], v[250:251], v[114:115], v[106:107]
  v_pk_fma_f32 v[252:253], v[252:253], v[116:117], v[108:109]
  v_pk_fma_f32 v[254:255], v[254:255], v[118:119], v[110:111]
  v_cvt_pk_bf16_f32 v124, v248, v249
  v_cvt_pk_bf16_f32 v125, v250, v251
  v_cvt_pk_bf16_f32 v126, v252, v253
  v_cvt_pk_bf16_f32 v127, v254, v255
  ds_read_b64_tr_b16 v[80:81], v9 offset:15360
  ds_read_b64_tr_b16 v[82:83], v9 offset:15616
  s_waitcnt lgkmcnt(6)
  v_mfma_f32_32x32x16_bf16 v[32:47], v[120:123], v[68:71], v[32:47]
  ds_read_b64_tr_b16 v[84:85], v8 offset:15360
  ds_read_b64_tr_b16 v[86:87], v8 offset:15616
  s_waitcnt lgkmcnt(6)
  v_mfma_f32_32x32x16_bf16 v[48:63], v[72:75], v[120:123], v[48:63]
  s_waitcnt lgkmcnt(4)
  v_mfma_f32_32x32x16_bf16 v[16:31], v[76:79], v[124:127], v[16:31]
  s_waitcnt lgkmcnt(2)
  v_mfma_f32_32x32x16_bf16 v[32:47], v[124:127], v[80:83], v[32:47]
  s_waitcnt lgkmcnt(0)
  v_mfma_f32_32x32x16_bf16 v[48:63], v[84:87], v[124:127], v[48:63]
  s_lshl_b32 s30, s9, 17
  s_lshl_b32 s27, s24, 10
  s_add_u32 s31, s30, s27
  s_add_u32 s30, s31, s27
  s_add_u32 s31, s31, 12582912
  s_add_u32 s30, s30, 14680064
  s_add_u32 s32, s31, 0x10000
  s_lshl_b32 s27, s7, 10
  v_add_u32 v8, s27, v14
  v_add_u32 v9, s27, v15
  v_add_u32 v10, s27, v8
  v_add_u32 v11, s27, v9
  s_mul_i32 s27, s7, 12288
  v_add_u32 v7, s27, v2
  s_cmp_ge_u32 s4, 4
  s_cbranch_scc1 p1_L
  s_barrier
  ds_write_b128 v7, v[48:51] offset:8192
  ds_write_b128 v7, v[52:55] offset:9216
  ds_write_b128 v7, v[56:59] offset:10240
  ds_write_b128 v7, v[60:63] offset:11264
  s_waitcnt lgkmcnt(0)
  s_barrier
  ds_read_b128 v[64:67], v7 offset:0
  ds_read_b128 v[68:71], v7 offset:1024
  ds_read_b128 v[72:75], v7 offset:2048
  ds_read_b128 v[76:79], v7 offset:3072
  ds_read_b128 v[80:83], v7 offset:4096
  ds_read_b128 v[84:87], v7 offset:5120
  ds_read_b128 v[88:91], v7 offset:6144
  ds_read_b128 v[92:95], v7 offset:7168
  s_waitcnt lgkmcnt(4)
  v_pk_add_f32 v[16:17], v[16:17], v[64:65]
  v_pk_add_f32 v[18:19], v[18:19], v[66:67]
  v_pk_add_f32 v[20:21], v[20:21], v[68:69]
  v_pk_add_f32 v[22:23], v[22:23], v[70:71]
  v_pk_add_f32 v[24:25], v[24:25], v[72:73]
  v_pk_add_f32 v[26:27], v[26:27], v[74:75]
  v_pk_add_f32 v[28:29], v[28:29], v[76:77]
  v_pk_add_f32 v[30:31], v[30:31], v[78:79]
  v_cvt_pk_bf16_f32 v104, v16, v17
  v_cvt_pk_bf16_f32 v105, v18, v19
  v_cvt_pk_bf16_f32 v106, v20, v21
  v_cvt_pk_bf16_f32 v107, v22, v23
  v_cvt_pk_bf16_f32 v108, v24, v25
  v_cvt_pk_bf16_f32 v109, v26, v27
  v_cvt_pk_bf16_f32 v110, v28, v29
  v_cvt_pk_bf16_f32 v111, v30, v31
  buffer_store_dwordx4 v[104:107], v2, s[12:15], s31 offen sc1
  ds_write_b128 v8, v[104:107] offset:40960
  buffer_store_dwordx4 v[108:111], v2, s[12:15], s32 offen sc1
  ds_write_b128 v8, v[108:111] offset:53248
  s_waitcnt lgkmcnt(2)
  v_pk_add_f32 v[32:33], v[32:33], v[80:81]
  v_pk_add_f32 v[34:35], v[34:35], v[82:83]
  v_pk_add_f32 v[36:37], v[36:37], v[84:85]
  v_pk_add_f32 v[38:39], v[38:39], v[86:87]
  v_pk_add_f32 v[40:41], v[40:41], v[88:89]
  v_pk_add_f32 v[42:43], v[42:43], v[90:91]
  v_pk_add_f32 v[44:45], v[44:45], v[92:93]
  v_pk_add_f32 v[46:47], v[46:47], v[94:95]
  v_cvt_pk_bf16_f32 v112, v32, v33
  v_cvt_pk_bf16_f32 v113, v34, v35
  v_cvt_pk_bf16_f32 v114, v36, v37
  v_cvt_pk_bf16_f32 v115, v38, v39
  v_cvt_pk_bf16_f32 v116, v40, v41
  v_cvt_pk_bf16_f32 v117, v42, v43
  v_cvt_pk_bf16_f32 v118, v44, v45
  v_cvt_pk_bf16_f32 v119, v46, v47
  buffer_store_dwordx4 v[112:115], v2, s[12:15], s30 offen sc1
  ds_write_b128 v11, v[112:115] offset:8192
  buffer_store_dwordx4 v[116:119], v2, s[12:15], s30 offen offset:1024 sc1
  ds_write_b128 v11, v[116:119] offset:9216
  s_branch p1_J
p1_L:
  s_barrier
  ds_write_b128 v7, v[16:19] offset:0
  ds_write_b128 v7, v[20:23] offset:1024
  ds_write_b128 v7, v[24:27] offset:2048
  ds_write_b128 v7, v[28:31] offset:3072
  ds_write_b128 v7, v[32:35] offset:4096
  ds_write_b128 v7, v[36:39] offset:5120
  ds_write_b128 v7, v[40:43] offset:6144
  ds_write_b128 v7, v[44:47] offset:7168
  s_waitcnt lgkmcnt(0)
  s_barrier
  ds_read_b128 v[64:67], v7 offset:8192
  ds_read_b128 v[68:71], v7 offset:9216
  ds_read_b128 v[72:75], v7 offset:10240
  ds_read_b128 v[76:79], v7 offset:11264
  s_mov_b32 s33, 0x3eb8aa3b
  v_mov_b32 v16, 0x3f803f80
  v_mov_b32 v17, v16
  v_mov_b32 v18, v16
  v_mov_b32 v19, v16
  ds_write_b128 v15, v[16:19] offset:31744
  s_waitcnt lgkmcnt(0)
  v_add_f32 v48, v48, v64
  v_mul_f32 v48, s33, v48
  v_add_f32 v49, v49, v65
  v_mul_f32 v49, s33, v49
  v_add_f32 v50, v50, v66
  v_mul_f32 v50, s33, v50
  v_add_f32 v51, v51, v67
  v_mul_f32 v51, s33, v51
  v_add_f32 v52, v52, v68
  v_mul_f32 v52, s33, v52
  v_add_f32 v53, v53, v69
  v_mul_f32 v53, s33, v53
  v_add_f32 v54, v54, v70
  v_mul_f32 v54, s33, v54
  v_add_f32 v55, v55, v71
  v_mul_f32 v55, s33, v55
  v_add_f32 v56, v56, v72
  v_mul_f32 v56, s33, v56
  v_add_f32 v57, v57, v73
  v_mul_f32 v57, s33, v57
  v_add_f32 v58, v58, v74
  v_mul_f32 v58, s33, v58
  v_add_f32 v59, v59, v75
  v_mul_f32 v59, s33, v59
  v_add_f32 v60, v60, v76
  v_mul_f32 v60, s33, v60
  v_add_f32 v61, v61, v77
  v_mul_f32 v61, s33, v61
  v_add_f32 v62, v62, v78
  v_mul_f32 v62, s33, v62
  v_add_f32 v63, v63, v79
  v_mul_f32 v63, s33, v63
  v_cvt_pk_bf16_f32 v64, v48, v49
  v_cvt_pk_bf16_f32 v65, v50, v51
  v_cvt_pk_bf16_f32 v66, v52, v53
  v_cvt_pk_bf16_f32 v67, v54, v55
  v_cvt_pk_bf16_f32 v68, v56, v57
  v_cvt_pk_bf16_f32 v69, v58, v59
  v_cvt_pk_bf16_f32 v70, v60, v61
  v_cvt_pk_bf16_f32 v71, v62, v63
  ds_write_b128 v9, v[64:67] offset:16384
  ds_write_b128 v9, v[68:71] offset:20480
p1_J:
  s_waitcnt lgkmcnt(0)
  s_cmp_ge_u32 s4, 4
  s_cbranch_scc1 arr1w
  s_waitcnt vmcnt(0)
arr1w:
  s_barrier
  s_cmp_lg_u32 s4, 0
  s_cbranch_scc1 arr1
  s_mov_b64 exec, 1
  v_mov_b32 v5, 30932992
  v_mov_b32 v6, s60
  buffer_store_dword v6, v5, s[12:15], s5 offen sc1
  s_mov_b64 exec, -1
arr1:
  v_lshlrev_b32 v7, 2, v4
  v_sub_u32 v7, v3, v7
  s_mov_b32 s31, 0xf149f2ca
  v_mov_b32 v8, s31
  v_mov_b32 v9, 0
  v_cmp_gt_i32 s[52:53], 0, v7
  v_cmp_gt_i32 s[54:55], 1, v7
  v_cmp_gt_i32 s[56:57], 2, v7
  v_cmp_gt_i32 s[58:59], 3, v7
  v_cndmask_b32 v112, v8, v9, s[52:53]
  v_cndmask_b32 v128, v9, v8, s[52:53]
  v_cndmask_b32 v113, v8, v9, s[54:55]
  v_cndmask_b32 v129, v9, v8, s[54:55]
  v_cndmask_b32 v114, v8, v9, s[56:57]
  v_cndmask_b32 v130, v9, v8, s[56:57]
  v_cndmask_b32 v115, v8, v9, s[58:59]
  v_cndmask_b32 v131, v9, v8, s[58:59]
  v_cmp_gt_i32 s[52:53], 8, v7
  v_cmp_gt_i32 s[54:55], 9, v7
  v_cmp_gt_i32 s[56:57], 10, v7
  v_cmp_gt_i32 s[58:59], 11, v7
  v_cndmask_b32 v116, v8, v9, s[52:53]
  v_cndmask_b32 v132, v9, v8, s[52:53]
  v_cndmask_b32 v117, v8, v9, s[54:55]
  v_cndmask_b32 v133, v9, v8, s[54:55]
  v_cndmask_b32 v118, v8, v9, s[56:57]
  v_cndmask_b32 v134, v9, v8, s[56:57]
  v_cndmask_b32 v119, v8, v9, s[58:59]
  v_cndmask_b32 v135, v9, v8, s[58:59]
  v_cmp_gt_i32 s[52:53], 16, v7
  v_cmp_gt_i32 s[54:55], 17, v7
  v_cmp_gt_i32 s[56:57], 18, v7
  v_cmp_gt_i32 s[58:59], 19, v7
  v_cndmask_b32 v120, v8, v9, s[52:53]
  v_cndmask_b32 v136, v9, v8, s[52:53]
  v_cndmask_b32 v121, v8, v9, s[54:55]
  v_cndmask_b32 v137, v9, v8, s[54:55]
  v_cndmask_b32 v122, v8, v9, s[56:57]
  v_cndmask_b32 v138, v9, v8, s[56:57]
  v_cndmask_b32 v123, v8, v9, s[58:59]
  v_cndmask_b32 v139, v9, v8, s[58:59]
  v_cmp_gt_i32 s[52:53], 24, v7
  v_cmp_gt_i32 s[54:55], 25, v7
  v_cmp_gt_i32 s[56:57], 26, v7
  v_cmp_gt_i32 s[58:59], 27, v7
  v_cndmask_b32 v124, v8, v9, s[52:53]
  v_cndmask_b32 v140, v9, v8, s[52:53]
  v_cndmask_b32 v125, v8, v9, s[54:55]
  v_cndmask_b32 v141, v9, v8, s[54:55]
  v_cndmask_b32 v126, v8, v9, s[56:57]
  v_cndmask_b32 v142, v9, v8, s[56:57]
  v_cndmask_b32 v127, v8, v9, s[58:59]
  v_cndmask_b32 v143, v9, v8, s[58:59]
  s_lshl_b32 s28, s8, 2
  s_add_u32 s28, s28, s4
  s_sub_u32 s28, s28, 8
  s_max_i32 s28, s28, 0
  s_lshl_b32 s27, s9, 17
  s_lshl_b32 s35, s28, 10
  s_add_u32 s36, s35, s27
  s_add_u32 s35, s36, s35
  s_add_u32 s36, s36, 12582912
  s_add_u32 s35, s35, 14680064
  s_lshl_b32 s38, s4, 10
  s_lshr_b32 s37, s4, 2
  s_mul_i32 s27, s37, 12288
  s_lshl_b32 s28, s7, 10
  s_add_u32 s27, s27, s28
  s_add_u32 s27, s27, 98304
  v_add_u32 v13, s27, v2
  s_lshl_b32 s27, s37, 8
  s_lshl_b32 s28, s7, 11
  s_add_u32 s27, s27, s28
  s_add_u32 s27, s27, 122880
  v_add_u32 v12, s27, v2
  v_cmp_gt_u32 vcc, 16, v3
  v_mov_b32 v10, 0x400
  v_mov_b32 v11, 162816
  v_cndmask_b32 v10, 0, v10, vcc
  v_cndmask_b32 v12, v11, v12, vcc
  v_add_u32 v11, s38, v15
  s_cmp_lt_u32 s4, 4
  s_cbranch_scc1 p2_ld
  s_waitcnt vmcnt(0)
p2_ld:
  s_cmp_lg_u32 s4, 3
  s_cbranch_scc1 pol2e
  s_mov_b32 s50, 0x40000
  s_sub_u32 s27, s5, 2048
  s_cselect_b32 s27, s5, s27
  s_sub_u32 s28, s5, 4096
  s_cselect_b32 s28, s5, s28
  v_mov_b32 v5, s27
  v_mov_b32 v6, s28
  v_cndmask_b32 v5, v5, v6, vcc
  v_add_u32 v5, 30932992, v5
pol2:
  buffer_load_dword v6, v5, s[12:15], 0 offen sc1
  s_waitcnt vmcnt(0)
  v_cmp_ne_u32 vcc, s60, v6
  s_cbranch_vccz pol2e
  s_sub_u32 s50, s50, 1
  s_cbranch_scc0 pol2
pol2e:
  s_barrier
  s_cmp_lg_u32 s4, 4
  s_cbranch_scc1 p1_nf
  s_lshl_b32 s27, s2, 7
  v_mov_b32 v5, 31096832
  v_mov_b32 v6, s60
  s_mov_b64 exec, 1
  buffer_store_dword v6, v5, s[12:15], s27 offen sc1
  s_mov_b64 exec, -1
p1_nf:
  s_add_u32 m0, s38, 98304
  s_add_u32 s27, s36, 0
  buffer_load_dwordx4 v2, s[12:15], s27 offen sc1 lds
  s_add_u32 m0, s38, 110592
  s_add_u32 s27, s36, 65536
  buffer_load_dwordx4 v2, s[12:15], s27 offen sc1 lds
  s_lshl_b32 s38, s38, 1
  s_add_u32 m0, s38, 122880
  s_add_u32 s27, s35, 0
  buffer_load_dwordx4 v2, s[12:15], s27 offen sc1 lds
  s_add_u32 m0, s38, 123904
  s_add_u32 s27, s35, 1024
  buffer_load_dwordx4 v2, s[12:15], s27 offen sc1 lds
  ds_read_b128 v[32:35], v11 offset:16384
  s_waitcnt vmcnt(0)
  s_waitcnt lgkmcnt(0)
  s_barrier
  s_mul_i32 s29, s4, 12288
  s_add_u32 s28, s41, s29
  s_mov_b32 vcc_hi, 0
  s_mov_b32 vcc_lo, s37
  s_cmp_lt_u32 s8, 2
  s_cbranch_scc1 p2_slow
  ds_read_b128 v[208:211], v13 offset:0
  ds_read_b128 v[212:215], v13 offset:1024
  ds_read_b128 v[216:219], v13 offset:2048
  ds_read_b128 v[220:223], v13 offset:3072
  ds_read_b128 v[224:227], v13 offset:4096
  ds_read_b128 v[228:231], v13 offset:5120
  ds_read_b128 v[232:235], v13 offset:6144
  ds_read_b128 v[236:239], v13 offset:7168
  ds_read_b128 v[240:243], v13 offset:8192
  s_waitcnt lgkmcnt(8)
  v_mfma_f32_32x32x16_bf16 v[160:175], v[208:211], v[32:35], v[112:127]
  s_waitcnt lgkmcnt(7)
  v_mfma_f32_32x32x16_bf16 v[176:191], v[212:215], v[32:35], 0
  s_nop 5
  s_waitcnt lgkmcnt(6)
  v_mfma_f32_32x32x16_bf16 v[192:207], v[216:219], v[32:35], 0
  s_nop 3
  v_max_f32 v8, v160, v161
  v_max_f32 v9, v162, v163
  v_max3_f32 v8, v8, v164, v165
  v_max3_f32 v9, v9, v166, v167
  v_max3_f32 v8, v8, v168, v169
  v_max3_f32 v9, v9, v170, v171
  v_max3_f32 v8, v8, v172, v173
  v_max3_f32 v9, v9, v174, v175
  s_waitcnt lgkmcnt(5)
  v_mfma_f32_32x32x16_bf16 v[160:175], v[220:223], v[32:35], 0
  v_max3_f32 v8, v8, v176, v177
  v_max3_f32 v9, v9, v178, v179
  v_max3_f32 v8, v8, v180, v181
  v_max3_f32 v9, v9, v182, v183
  v_max3_f32 v8, v8, v184, v185
  v_max3_f32 v9, v9, v186, v187
  v_max3_f32 v8, v8, v188, v189
  v_max3_f32 v9, v9, v190, v191
  s_waitcnt lgkmcnt(4)
  v_mfma_f32_32x32x16_bf16 v[176:191], v[224:227], v[32:35], 0
  v_max3_f32 v8, v8, v192, v193
  v_max3_f32 v9, v9, v194, v195
  v_max3_f32 v8, v8, v196, v197
  v_max3_f32 v9, v9, v198, v199
  v_max3_f32 v8, v8, v200, v201
  v_max3_f32 v9, v9, v202, v203
  v_max3_f32 v8, v8, v204, v205
  v_max3_f32 v9, v9, v206, v207
  s_waitcnt lgkmcnt(3)
  v_mfma_f32_32x32x16_bf16 v[192:207], v[228:231], v[32:35], 0
  v_max3_f32 v8, v8, v160, v161
  v_max3_f32 v9, v9, v162, v163
  v_max3_f32 v8, v8, v164, v165
  v_max3_f32 v9, v9, v166, v167
  v_max3_f32 v8, v8, v168, v169
  v_max3_f32 v9, v9, v170, v171
  v_max3_f32 v8, v8, v172, v173
  v_max3_f32 v9, v9, v174, v175
  s_waitcnt lgkmcnt(2)
  v_mfma_f32_32x32x16_bf16 v[160:175], v[232:235], v[32:35], 0
  v_max3_f32 v8, v8, v176, v177
  v_max3_f32 v9, v9, v178, v179
  v_max3_f32 v8, v8, v180, v181
  v_max3_f32 v9, v9, v182, v183
  v_max3_f32 v8, v8, v184, v185
  v_max3_f32 v9, v9, v186, v187
  v_max3_f32 v8, v8, v188, v189
  v_max3_f32 v9, v9, v190, v191
  s_waitcnt lgkmcnt(1)
  v_mfma_f32_32x32x16_bf16 v[176:191], v[236:239], v[32:35], 0
  v_max3_f32 v8, v8, v192, v193
  v_max3_f32 v9, v9, v194, v195
  v_max3_f32 v8, v8, v196, v197
  v_max3_f32 v9, v9, v198, v199
  v_max3_f32 v8, v8, v200, v201
  v_max3_f32 v9, v9, v202, v203
  v_max3_f32 v8, v8, v204, v205
  v_max3_f32 v9, v9, v206, v207
  s_waitcnt lgkmcnt(0)
  v_mfma_f32_32x32x16_bf16 v[192:207], v[240:243], v[32:35], v[128:143]
  v_max3_f32 v8, v8, v160, v161
  v_max3_f32 v9, v9, v162, v163
  v_max3_f32 v8, v8, v164, v165
  v_max3_f32 v9, v9, v166, v167
  v_max3_f32 v8, v8, v168, v169
  v_max3_f32 v9, v9, v170, v171
  v_max3_f32 v8, v8, v172, v173
  v_max3_f32 v9, v9, v174, v175
  v_max3_f32 v8, v8, v176, v177
  v_max3_f32 v9, v9, v178, v179
  v_max3_f32 v8, v8, v180, v181
  v_max3_f32 v9, v9, v182, v183
  v_max3_f32 v8, v8, v184, v185
  v_max3_f32 v9, v9, v186, v187
  v_max3_f32 v8, v8, v188, v189
  v_max3_f32 v9, v9, v190, v191
  ds_read_b128 v[36:39], v12 offset:0
  v_add_u32 v12, v12, v10
  ds_read_b128 v[40:43], v12 offset:0
  v_add_u32 v12, v12, v10
  v_max3_f32 v8, v8, v192, v193
  v_max3_f32 v9, v9, v194, v195
  v_max3_f32 v8, v8, v196, v197
  v_max3_f32 v9, v9, v198, v199
  v_max3_f32 v8, v8, v200, v201
  v_max3_f32 v9, v9, v202, v203
  v_max3_f32 v8, v8, v204, v205
  v_max3_f32 v9, v9, v206, v207
  v_max_f32 v8, v8, v9
  v_mov_b32 v9, v8
  s_nop 1
  v_permlane32_swap_b32 v9, v8
  s_nop 1
  v_max_f32 v8, v8, v9
  v_sub_f32 v112, v112, v8
  v_sub_f32 v113, v113, v8
  v_sub_f32 v114, v114, v8
  v_sub_f32 v115, v115, v8
  v_sub_f32 v116, v116, v8
  v_sub_f32 v117, v117, v8
  v_sub_f32 v118, v118, v8
  v_sub_f32 v119, v119, v8
  v_sub_f32 v120, v120, v8
  v_sub_f32 v121, v121, v8
  v_sub_f32 v122, v122, v8
  v_sub_f32 v123, v123, v8
  v_sub_f32 v124, v124, v8
  v_sub_f32 v125, v125, v8
  v_sub_f32 v126, v126, v8
  v_sub_f32 v127, v127, v8
  v_sub_f32 v144, 0, v8
  v_sub_f32 v145, 0, v8
  v_sub_f32 v146, 0, v8
  v_sub_f32 v147, 0, v8
  v_sub_f32 v148, 0, v8
  v_sub_f32 v149, 0, v8
  v_sub_f32 v150, 0, v8
  v_sub_f32 v151, 0, v8
  v_sub_f32 v152, 0, v8
  v_sub_f32 v153, 0, v8
  v_sub_f32 v154, 0, v8
  v_sub_f32 v155, 0, v8
  v_sub_f32 v156, 0, v8
  v_sub_f32 v157, 0, v8
  v_sub_f32 v158, 0, v8
  v_sub_f32 v159, 0, v8
  v_sub_f32 v128, v128, v8
  v_sub_f32 v129, v129, v8
  v_sub_f32 v130, v130, v8
  v_sub_f32 v131, v131, v8
  v_sub_f32 v132, v132, v8
  v_sub_f32 v133, v133, v8
  v_sub_f32 v134, v134, v8
  v_sub_f32 v135, v135, v8
  v_sub_f32 v136, v136, v8
  v_sub_f32 v137, v137, v8
  v_sub_f32 v138, v138, v8
  v_sub_f32 v139, v139, v8
  v_sub_f32 v140, v140, v8
  v_sub_f32 v141, v141, v8
  v_sub_f32 v142, v142, v8
  v_sub_f32 v143, v143, v8
  v_mfma_f32_32x32x16_bf16 v[160:175], v[208:211], v[32:35], v[112:127]
  v_mfma_f32_32x32x16_bf16 v[176:191], v[212:215], v[32:35], v[144:159]
  s_nop 7
  s_nop 3
  v_exp_f32 v160, v160
  v_exp_f32 v161, v161
  v_exp_f32 v162, v162
  v_exp_f32 v163, v163
  v_exp_f32 v164, v164
  v_exp_f32 v165, v165
  v_exp_f32 v166, v166
  v_exp_f32 v167, v167
  v_mfma_f32_32x32x16_bf16 v[192:207], v[216:219], v[32:35], v[144:159]
  ds_read_b128 v[44:47], v12 offset:0
  v_add_u32 v12, v12, v10
  v_cvt_pk_bf16_f32 v160, v160, v161
  v_cvt_pk_bf16_f32 v161, v162, v163
  v_cvt_pk_bf16_f32 v162, v164, v165
  v_cvt_pk_bf16_f32 v163, v166, v167
  v_exp_f32 v168, v168
  v_exp_f32 v169, v169
  v_exp_f32 v170, v170
  v_exp_f32 v171, v171
  v_exp_f32 v172, v172
  v_exp_f32 v173, v173
  v_exp_f32 v174, v174
  v_exp_f32 v175, v175
  s_waitcnt lgkmcnt(2)
  v_mfma_f32_32x32x16_bf16 v[16:31], v[36:39], v[160:163], 0
  ds_read_b128 v[36:39], v12 offset:0
  v_add_u32 v12, v12, v10
  v_cvt_pk_bf16_f32 v168, v168, v169
  v_cvt_pk_bf16_f32 v169, v170, v171
  v_cvt_pk_bf16_f32 v170, v172, v173
  v_cvt_pk_bf16_f32 v171, v174, v175
  v_exp_f32 v176, v176
  v_exp_f32 v177, v177
  v_exp_f32 v178, v178
  v_exp_f32 v179, v179
  v_exp_f32 v180, v180
  v_exp_f32 v181, v181
  v_exp_f32 v182, v182
  v_exp_f32 v183, v183
  s_waitcnt lgkmcnt(2)
  v_mfma_f32_32x32x16_bf16 v[16:31], v[40:43], v[168:171], v[16:31]
  v_mfma_f32_32x32x16_bf16 v[160:175], v[220:223], v[32:35], v[144:159]
  ds_read_b128 v[40:43], v12 offset:0
  v_add_u32 v12, v12, v10
  v_cvt_pk_bf16_f32 v176, v176, v177
  v_cvt_pk_bf16_f32 v177, v178, v179
  v_cvt_pk_bf16_f32 v178, v180, v181
  v_cvt_pk_bf16_f32 v179, v182, v183
  v_exp_f32 v184, v184
  v_exp_f32 v185, v185
  v_exp_f32 v186, v186
  v_exp_f32 v187, v187
  v_exp_f32 v188, v188
  v_exp_f32 v189, v189
  v_exp_f32 v190, v190
  v_exp_f32 v191, v191
  s_waitcnt lgkmcnt(2)
  v_mfma_f32_32x32x16_bf16 v[16:31], v[44:47], v[176:179], v[16:31]
  ds_read_b128 v[44:47], v12 offset:0
  v_add_u32 v12, v12, v10
  v_cvt_pk_bf16_f32 v184, v184, v185
  v_cvt_pk_bf16_f32 v185, v186, v187
  v_cvt_pk_bf16_f32 v186, v188, v189
  v_cvt_pk_bf16_f32 v187, v190, v191
  v_exp_f32 v192, v192
  v_exp_f32 v193, v193
  v_exp_f32 v194, v194
  v_exp_f32 v195, v195
  v_exp_f32 v196, v196
  v_exp_f32 v197, v197
  v_exp_f32 v198, v198
  v_exp_f32 v199, v199
  s_waitcnt lgkmcnt(2)
  v_mfma_f32_32x32x16_bf16 v[16:31], v[36:39], v[184:187], v[16:31]
  v_mfma_f32_32x32x16_bf16 v[176:191], v[224:227], v[32:35], v[144:159]
  ds_read_b128 v[36:39], v12 offset:0
  v_add_u32 v12, v12, v10
  s_cmp_lt_u32 s4, 4
  s_cbranch_scc1 p2_f0e
  s_lshl_b32 s27, s7, 13
  s_add_u32 s27, s27, 31096832
  v_lshlrev_b32 v5, 7, v1
  v_add_u32 v5, s27, v5
  s_mov_b32 s50, 0x40000
p2_f0:
  buffer_load_dword v6, v5, s[12:15], 0 offen offset:0 sc1
  s_waitcnt vmcnt(0)
  v_cmp_ne_u32 vcc, s60, v6
  s_cbranch_vccz p2_f0e
  s_sleep 1
  s_sub_u32 s50, s50, 1
  s_cbranch_scc0 p2_f0
p2_f0e:
  s_barrier
  s_add_u32 s30, s40, 0
  buffer_load_dwordx4 v[48:51], v2, s[12:15], s30 offen sc1
  s_add_u32 m0, s29, 0
  s_add_u32 s27, s28, 0
  buffer_load_dwordx4 v2, s[12:15], s27 offen sc1 lds
  v_cvt_pk_bf16_f32 v192, v192, v193
  v_cvt_pk_bf16_f32 v193, v194, v195
  v_cvt_pk_bf16_f32 v194, v196, v197
  v_cvt_pk_bf16_f32 v195, v198, v199
  v_exp_f32 v200, v200
  v_exp_f32 v201, v201
  v_exp_f32 v202, v202
  v_exp_f32 v203, v203
  v_exp_f32 v204, v204
  v_exp_f32 v205, v205
  v_exp_f32 v206, v206
  v_exp_f32 v207, v207
  s_waitcnt lgkmcnt(2)
  v_mfma_f32_32x32x16_bf16 v[16:31], v[40:43], v[192:195], v[16:31]
  ds_read_b128 v[40:43], v12 offset:0
  v_add_u32 v12, v12, v10
  buffer_load_dwordx4 v[52:55], v2, s[12:15], s30 offen offset:1024 sc1
  s_add_u32 m0, s29, 1024
  s_add_u32 s27, s28, 1024
  buffer_load_dwordx4 v2, s[12:15], s27 offen sc1 lds
  v_cvt_pk_bf16_f32 v200, v200, v201
  v_cvt_pk_bf16_f32 v201, v202, v203
  v_cvt_pk_bf16_f32 v202, v204, v205
  v_cvt_pk_bf16_f32 v203, v206, v207
  v_exp_f32 v160, v160
  v_exp_f32 v161, v161
  v_exp_f32 v162, v162
  v_exp_f32 v163, v163
  v_exp_f32 v164, v164
  v_exp_f32 v165, v165
  v_exp_f32 v166, v166
  v_exp_f32 v167, v167
  s_waitcnt lgkmcnt(2)
  v_mfma_f32_32x32x16_bf16 v[16:31], v[44:47], v[200:203], v[16:31]
  v_mfma_f32_32x32x16_bf16 v[192:207], v[228:231], v[32:35], v[144:159]
  ds_read_b128 v[44:47], v12 offset:0
  v_add_u32 v12, v12, v10
  buffer_load_dwordx4 v[56:59], v2, s[12:15], s30 offen offset:2048 sc1
  s_add_u32 m0, s29, 2048
  s_add_u32 s27, s28, 2048
  buffer_load_dwordx4 v2, s[12:15], s27 offen sc1 lds
  v_cvt_pk_bf16_f32 v160, v160, v161
  v_cvt_pk_bf16_f32 v161, v162, v163
  v_cvt_pk_bf16_f32 v162, v164, v165
  v_cvt_pk_bf16_f32 v163, v166, v167
  v_exp_f32 v168, v168
  v_exp_f32 v169, v169
  v_exp_f32 v170, v170
  v_exp_f32 v171, v171
  v_exp_f32 v172, v172
  v_exp_f32 v173, v173
  v_exp_f32 v174, v174
  v_exp_f32 v175, v175
  s_waitcnt lgkmcnt(2)
  v_mfma_f32_32x32x16_bf16 v[16:31], v[36:39], v[160:163], v[16:31]
  ds_read_b128 v[36:39], v12 offset:0
  v_add_u32 v12, v12, v10
  buffer_load_dwordx4 v[60:63], v2, s[12:15], s30 offen offset:3072 sc1
  s_add_u32 m0, s29, 3072
  s_add_u32 s27, s28, 3072
  buffer_load_dwordx4 v2, s[12:15], s27 offen sc1 lds
  v_cvt_pk_bf16_f32 v168, v168, v169
  v_cvt_pk_bf16_f32 v169, v170, v171
  v_cvt_pk_bf16_f32 v170, v172, v173
  v_cvt_pk_bf16_f32 v171, v174, v175
  v_exp_f32 v176, v176
  v_exp_f32 v177, v177
  v_exp_f32 v178, v178
  v_exp_f32 v179, v179
  v_exp_f32 v180, v180
  v_exp_f32 v181, v181
  v_exp_f32 v182, v182
  v_exp_f32 v183, v183
  s_waitcnt lgkmcnt(2)
  v_mfma_f32_32x32x16_bf16 v[16:31], v[40:43], v[168:171], v[16:31]
  v_mfma_f32_32x32x16_bf16 v[160:175], v[232:235], v[32:35], v[144:159]
  ds_read_b128 v[40:43], v12 offset:0
  v_add_u32 v12, v12, v10
  s_add_u32 s30, s40, 4096
  buffer_load_dwordx4 v[64:67], v2, s[12:15], s30 offen sc1
  s_add_u32 m0, s29, 4096
  s_add_u32 s27, s28, 4096
  buffer_load_dwordx4 v2, s[12:15], s27 offen sc1 lds
  v_cvt_pk_bf16_f32 v176, v176, v177
  v_cvt_pk_bf16_f32 v177, v178, v179
  v_cvt_pk_bf16_f32 v178, v180, v181
  v_cvt_pk_bf16_f32 v179, v182, v183
  v_exp_f32 v184, v184
  v_exp_f32 v185, v185
  v_exp_f32 v186, v186
  v_exp_f32 v187, v187
  v_exp_f32 v188, v188
  v_exp_f32 v189, v189
  v_exp_f32 v190, v190
  v_exp_f32 v191, v191
  s_waitcnt lgkmcnt(2)
  v_mfma_f32_32x32x16_bf16 v[16:31], v[44:47], v[176:179], v[16:31]
  ds_read_b128 v[44:47], v12 offset:0
  v_add_u32 v12, v12, v10
  buffer_load_dwordx4 v[68:71], v2, s[12:15], s30 offen offset:1024 sc1
  s_add_u32 m0, s29, 5120
  s_add_u32 s27, s28, 5120
  buffer_load_dwordx4 v2, s[12:15], s27 offen sc1 lds
  v_cvt_pk_bf16_f32 v184, v184, v185
  v_cvt_pk_bf16_f32 v185, v186, v187
  v_cvt_pk_bf16_f32 v186, v188, v189
  v_cvt_pk_bf16_f32 v187, v190, v191
  v_exp_f32 v192, v192
  v_exp_f32 v193, v193
  v_exp_f32 v194, v194
  v_exp_f32 v195, v195
  v_exp_f32 v196, v196
  v_exp_f32 v197, v197
  v_exp_f32 v198, v198
  v_exp_f32 v199, v199
  s_waitcnt lgkmcnt(2)
  v_mfma_f32_32x32x16_bf16 v[16:31], v[36:39], v[184:187], v[16:31]
  v_mfma_f32_32x32x16_bf16 v[176:191], v[236:239], v[32:35], v[144:159]
  ds_read_b128 v[36:39], v12 offset:0
  v_add_u32 v12, v12, v10
  buffer_load_dwordx4 v[72:75], v2, s[12:15], s30 offen offset:2048 sc1
  buffer_load_dwordx4 v[76:79], v2, s[12:15], s30 offen offset:3072 sc1
  v_cvt_pk_bf16_f32 v192, v192, v193
  v_cvt_pk_bf16_f32 v193, v194, v195
  v_cvt_pk_bf16_f32 v194, v196, v197
  v_cvt_pk_bf16_f32 v195, v198, v199
  v_exp_f32 v200, v200
  v_exp_f32 v201, v201
  v_exp_f32 v202, v202
  v_exp_f32 v203, v203
  v_exp_f32 v204, v204
  v_exp_f32 v205, v205
  v_exp_f32 v206, v206
  v_exp_f32 v207, v207
  s_waitcnt lgkmcnt(2)
  v_mfma_f32_32x32x16_bf16 v[16:31], v[40:43], v[192:195], v[16:31]
  ds_read_b128 v[40:43], v12 offset:0
  v_add_u32 v12, v12, v10
  s_add_u32 s30, s40, 8192
  buffer_load_dwordx4 v[80:83], v2, s[12:15], s30 offen sc1
  buffer_load_dwordx4 v[84:87], v2, s[12:15], s30 offen offset:1024 sc1
  v_cvt_pk_bf16_f32 v200, v200, v201
  v_cvt_pk_bf16_f32 v201, v202, v203
  v_cvt_pk_bf16_f32 v202, v204, v205
  v_cvt_pk_bf16_f32 v203, v206, v207
  v_exp_f32 v160, v160
  v_exp_f32 v161, v161
  v_exp_f32 v162, v162
  v_exp_f32 v163, v163
  v_exp_f32 v164, v164
  v_exp_f32 v165, v165
  v_exp_f32 v166, v166
  v_exp_f32 v167, v167
  s_waitcnt lgkmcnt(2)
  v_mfma_f32_32x32x16_bf16 v[16:31], v[44:47], v[200:203], v[16:31]
  v_mfma_f32_32x32x16_bf16 v[192:207], v[240:243], v[32:35], v[128:143]
  ds_read_b128 v[44:47], v12 offset:0
  v_add_u32 v12, v12, v10
  buffer_load_dwordx4 v[88:91], v2, s[12:15], s30 offen offset:2048 sc1
  buffer_load_dwordx4 v[92:95], v2, s[12:15], s30 offen offset:3072 sc1
  v_cvt_pk_bf16_f32 v160, v160, v161
  v_cvt_pk_bf16_f32 v161, v162, v163
  v_cvt_pk_bf16_f32 v162, v164, v165
  v_cvt_pk_bf16_f32 v163, v166, v167
  v_exp_f32 v168, v168
  v_exp_f32 v169, v169
  v_exp_f32 v170, v170
  v_exp_f32 v171, v171
  v_exp_f32 v172, v172
  v_exp_f32 v173, v173
  v_exp_f32 v174, v174
  v_exp_f32 v175, v175
  s_waitcnt lgkmcnt(2)
  v_mfma_f32_32x32x16_bf16 v[16:31], v[36:39], v[160:163], v[16:31]
  ds_read_b128 v[36:39], v12 offset:0
  v_add_u32 v12, v12, v10
  s_add_u32 s30, s40, 12288
  buffer_load_dwordx4 v[96:99], v2, s[12:15], s30 offen sc1
  buffer_load_dwordx4 v[100:103], v2, s[12:15], s30 offen offset:1024 sc1
  v_cvt_pk_bf16_f32 v168, v168, v169
  v_cvt_pk_bf16_f32 v169, v170, v171
  v_cvt_pk_bf16_f32 v170, v172, v173
  v_cvt_pk_bf16_f32 v171, v174, v175
  v_exp_f32 v176, v176
  v_exp_f32 v177, v177
  v_exp_f32 v178, v178
  v_exp_f32 v179, v179
  v_exp_f32 v180, v180
  v_exp_f32 v181, v181
  v_exp_f32 v182, v182
  v_exp_f32 v183, v183
  s_waitcnt lgkmcnt(2)
  v_mfma_f32_32x32x16_bf16 v[16:31], v[40:43], v[168:171], v[16:31]
  ds_read_b128 v[40:43], v12 offset:0
  v_add_u32 v12, v12, v10
  buffer_load_dwordx4 v[104:107], v2, s[12:15], s30 offen offset:2048 sc1
  buffer_load_dwordx4 v[108:111], v2, s[12:15], s30 offen offset:3072 sc1
  v_cvt_pk_bf16_f32 v176, v176, v177
  v_cvt_pk_bf16_f32 v177, v178, v179
  v_cvt_pk_bf16_f32 v178, v180, v181
  v_cvt_pk_bf16_f32 v179, v182, v183
  v_exp_f32 v184, v184
  v_exp_f32 v185, v185
  v_exp_f32 v186, v186
  v_exp_f32 v187, v187
  v_exp_f32 v188, v188
  v_exp_f32 v189, v189
  v_exp_f32 v190, v190
  v_exp_f32 v191, v191
  s_waitcnt lgkmcnt(2)
  v_mfma_f32_32x32x16_bf16 v[16:31], v[44:47], v[176:179], v[16:31]
  ds_read_b128 v[44:47], v12 offset:0
  v_add_u32 v12, v12, v10
  v_cvt_pk_bf16_f32 v184, v184, v185
  v_cvt_pk_bf16_f32 v185, v186, v187
  v_cvt_pk_bf16_f32 v186, v188, v189
  v_cvt_pk_bf16_f32 v187, v190, v191
  v_exp_f32 v192, v192
  v_exp_f32 v193, v193
  v_exp_f32 v194, v194
  v_exp_f32 v195, v195
  v_exp_f32 v196, v196
  v_exp_f32 v197, v197
  v_exp_f32 v198, v198
  v_exp_f32 v199, v199
  s_waitcnt lgkmcnt(2)
  v_mfma_f32_32x32x16_bf16 v[16:31], v[36:39], v[184:187], v[16:31]
  v_cvt_pk_bf16_f32 v192, v192, v193
  v_cvt_pk_bf16_f32 v193, v194, v195
  v_cvt_pk_bf16_f32 v194, v196, v197
  v_cvt_pk_bf16_f32 v195, v198, v199
  v_exp_f32 v200, v200
  v_exp_f32 v201, v201
  v_exp_f32 v202, v202
  v_exp_f32 v203, v203
  v_exp_f32 v204, v204
  v_exp_f32 v205, v205
  v_exp_f32 v206, v206
  v_exp_f32 v207, v207
  s_waitcnt lgkmcnt(1)
  v_mfma_f32_32x32x16_bf16 v[16:31], v[40:43], v[192:195], v[16:31]
  v_cvt_pk_bf16_f32 v200, v200, v201
  v_cvt_pk_bf16_f32 v201, v202, v203
  v_cvt_pk_bf16_f32 v202, v204, v205
  v_cvt_pk_bf16_f32 v203, v206, v207
  s_nop 1
  s_waitcnt lgkmcnt(0)
  v_mfma_f32_32x32x16_bf16 v[16:31], v[44:47], v[200:203], v[16:31]
  s_branch p2_join
p2_slow:
  s_sub_u32 s30, 8, s24
  s_lshl_b32 s27, s30, 10
  v_add_u32 v13, s27, v13
  v_mov_b32 v7, v13
  s_lshl_b32 s27, s30, 1
  v_mad_u32_u24 v12, v10, s27, v12
  v_mov_b32 v8, s31
  v_mov_b32 v9, s31
  v_mov_b32 v16, 0
  v_mov_b32 v17, 0
  v_mov_b32 v18, 0
  v_mov_b32 v19, 0
  v_mov_b32 v20, 0
  v_mov_b32 v21, 0
  v_mov_b32 v22, 0
  v_mov_b32 v23, 0
  v_mov_b32 v24, 0
  v_mov_b32 v25, 0
  v_mov_b32 v26, 0
  v_mov_b32 v27, 0
  v_mov_b32 v28, 0
  v_mov_b32 v29, 0
  v_mov_b32 v30, 0
  v_mov_b32 v31, 0
  s_mov_b32 s32, s30
p2_l0:
  ds_read_b128 v[208:211], v13 offset:0
  v_add_u32 v13, 0x400, v13
  s_waitcnt lgkmcnt(0)
  s_cmp_eq_u32 s32, 8
  s_cbranch_scc1 p2_m0
  v_mfma_f32_32x32x16_bf16 v[160:175], v[208:211], v[32:35], 0
  s_branch p2_n0
p2_m0:
  v_mfma_f32_32x32x16_bf16 v[160:175], v[208:211], v[32:35], v[128:143]
p2_n0:
  s_nop 7
  s_nop 3
  v_max3_f32 v8, v8, v160, v161
  v_max3_f32 v9, v9, v162, v163
  v_max3_f32 v8, v8, v164, v165
  v_max3_f32 v9, v9, v166, v167
  v_max3_f32 v8, v8, v168, v169
  v_max3_f32 v9, v9, v170, v171
  v_max3_f32 v8, v8, v172, v173
  v_max3_f32 v9, v9, v174, v175
  s_add_u32 s32, s32, 1
  s_cmp_le_u32 s32, 8
  s_cbranch_scc1 p2_l0
  v_max_f32 v8, v8, v9
  v_mov_b32 v9, v8
  s_nop 1
  v_permlane32_swap_b32 v9, v8
  s_nop 1
  v_max_f32 v8, v8, v9
  v_sub_f32 v144, 0, v8
  v_sub_f32 v145, 0, v8
  v_sub_f32 v146, 0, v8
  v_sub_f32 v147, 0, v8
  v_sub_f32 v148, 0, v8
  v_sub_f32 v149, 0, v8
  v_sub_f32 v150, 0, v8
  v_sub_f32 v151, 0, v8
  v_sub_f32 v152, 0, v8
  v_sub_f32 v153, 0, v8
  v_sub_f32 v154, 0, v8
  v_sub_f32 v155, 0, v8
  v_sub_f32 v156, 0, v8
  v_sub_f32 v157, 0, v8
  v_sub_f32 v158, 0, v8
  v_sub_f32 v159, 0, v8
  v_sub_f32 v128, v128, v8
  v_sub_f32 v129, v129, v8
  v_sub_f32 v130, v130, v8
  v_sub_f32 v131, v131, v8
  v_sub_f32 v132, v132, v8
  v_sub_f32 v133, v133, v8
  v_sub_f32 v134, v134, v8
  v_sub_f32 v135, v135, v8
  v_sub_f32 v136, v136, v8
  v_sub_f32 v137, v137, v8
  v_sub_f32 v138, v138, v8
  v_sub_f32 v139, v139, v8
  v_sub_f32 v140, v140, v8
  v_sub_f32 v141, v141, v8
  v_sub_f32 v142, v142, v8
  v_sub_f32 v143, v143, v8
  s_cmp_lt_u32 s4, 4
  s_cbranch_scc1 p2_f1e
  s_lshl_b32 s27, s7, 13
  s_add_u32 s27, s27, 31096832
  v_lshlrev_b32 v5, 7, v1
  v_add_u32 v5, s27, v5
  s_mov_b32 s50, 0x40000
p2_f1:
  buffer_load_dword v6, v5, s[12:15], 0 offen offset:0 sc1
  s_waitcnt vmcnt(0)
  v_cmp_ne_u32 vcc, s60, v6
  s_cbranch_vccz p2_f1e
  s_sleep 1
  s_sub_u32 s50, s50, 1
  s_cbranch_scc0 p2_f1
p2_f1e:
  s_barrier
  s_mov_b32 s49, s30
  s_add_u32 s30, s40, 0
  buffer_load_dwordx4 v[48:51], v2, s[12:15], s30 offen sc1
  buffer_load_dwordx4 v[52:55], v2, s[12:15], s30 offen offset:1024 sc1
  buffer_load_dwordx4 v[56:59], v2, s[12:15], s30 offen offset:2048 sc1
  buffer_load_dwordx4 v[60:63], v2, s[12:15], s30 offen offset:3072 sc1
  s_add_u32 s30, s40, 4096
  buffer_load_dwordx4 v[64:67], v2, s[12:15], s30 offen sc1
  buffer_load_dwordx4 v[68:71], v2, s[12:15], s30 offen offset:1024 sc1
  buffer_load_dwordx4 v[72:75], v2, s[12:15], s30 offen offset:2048 sc1
  buffer_load_dwordx4 v[76:79], v2, s[12:15], s30 offen offset:3072 sc1
  s_add_u32 s30, s40, 8192
  buffer_load_dwordx4 v[80:83], v2, s[12:15], s30 offen sc1
  buffer_load_dwordx4 v[84:87], v2, s[12:15], s30 offen offset:1024 sc1
  buffer_load_dwordx4 v[88:91], v2, s[12:15], s30 offen offset:2048 sc1
  buffer_load_dwordx4 v[92:95], v2, s[12:15], s30 offen offset:3072 sc1
  s_add_u32 s30, s40, 12288
  buffer_load_dwordx4 v[96:99], v2, s[12:15], s30 offen sc1
  buffer_load_dwordx4 v[100:103], v2, s[12:15], s30 offen offset:1024 sc1
  buffer_load_dwordx4 v[104:107], v2, s[12:15], s30 offen offset:2048 sc1
  buffer_load_dwordx4 v[108:111], v2, s[12:15], s30 offen offset:3072 sc1
  s_mov_b32 s30, s49
  s_mov_b32 s32, s30
p2_l1:
  ds_read_b128 v[208:211], v7 offset:0
  v_add_u32 v7, 0x400, v7
  ds_read_b128 v[36:39], v12 offset:0
  v_add_u32 v12, v12, v10
  ds_read_b128 v[40:43], v12 offset:0
  v_add_u32 v12, v12, v10
  s_waitcnt lgkmcnt(0)
  s_cmp_eq_u32 s32, 8
  s_cbranch_scc1 p2_m1
  v_mfma_f32_32x32x16_bf16 v[160:175], v[208:211], v[32:35], v[144:159]
  s_branch p2_n1
p2_m1:
  v_mfma_f32_32x32x16_bf16 v[160:175], v[208:211], v[32:35], v[128:143]
p2_n1:
  s_nop 7
  s_nop 3
  v_exp_f32 v160, v160
  v_exp_f32 v161, v161
  v_exp_f32 v162, v162
  v_exp_f32 v163, v163
  v_exp_f32 v164, v164
  v_exp_f32 v165, v165
  v_exp_f32 v166, v166
  v_exp_f32 v167, v167
  v_exp_f32 v168, v168
  v_exp_f32 v169, v169
  v_exp_f32 v170, v170
  v_exp_f32 v171, v171
  v_exp_f32 v172, v172
  v_exp_f32 v173, v173
  v_exp_f32 v174, v174
  v_exp_f32 v175, v175
  s_nop 0
  v_cvt_pk_bf16_f32 v176, v160, v161
  v_cvt_pk_bf16_f32 v177, v162, v163
  v_cvt_pk_bf16_f32 v178, v164, v165
  v_cvt_pk_bf16_f32 v179, v166, v167
  v_cvt_pk_bf16_f32 v180, v168, v169
  v_cvt_pk_bf16_f32 v181, v170, v171
  v_cvt_pk_bf16_f32 v182, v172, v173
  v_cvt_pk_bf16_f32 v183, v174, v175
  s_nop 1
  v_mfma_f32_32x32x16_bf16 v[16:31], v[36:39], v[176:179], v[16:31]
  v_mfma_f32_32x32x16_bf16 v[16:31], v[40:43], v[180:183], v[16:31]
  s_add_u32 s32, s32, 1
  s_cmp_le_u32 s32, 8
  s_cbranch_scc1 p2_l1
  s_add_u32 m0, s29, 0
  s_add_u32 s27, s28, 0
  buffer_load_dwordx4 v2, s[12:15], s27 offen sc1 lds
  s_add_u32 m0, s29, 1024
  s_add_u32 s27, s28, 1024
  buffer_load_dwordx4 v2, s[12:15], s27 offen sc1 lds
  s_add_u32 m0, s29, 2048
  s_add_u32 s27, s28, 2048
  buffer_load_dwordx4 v2, s[12:15], s27 offen sc1 lds
  s_add_u32 m0, s29, 3072
  s_add_u32 s27, s28, 3072
  buffer_load_dwordx4 v2, s[12:15], s27 offen sc1 lds
  s_add_u32 m0, s29, 4096
  s_add_u32 s27, s28, 4096
  buffer_load_dwordx4 v2, s[12:15], s27 offen sc1 lds
  s_add_u32 m0, s29, 5120
  s_add_u32 s27, s28, 5120
  buffer_load_dwordx4 v2, s[12:15], s27 offen sc1 lds
p2_join:
  s_lshl_b32 s30, s24, 15
  s_lshl_b32 s27, s9, 11
  s_add_u32 s30, s30, s27
  s_lshl_b32 s27, s37, 10
  s_add_u32 s30, s30, s27
  s_add_u32 s30, s30, 16777216
  s_nop 5
  v_rcp_f32 v8, v24
  s_nop 0
  v_mul_f32 v16, v16, v8
  v_mul_f32 v17, v17, v8
  v_mul_f32 v18, v18, v8
  v_mul_f32 v19, v19, v8
  v_mul_f32 v20, v20, v8
  v_mul_f32 v21, v21, v8
  v_mul_f32 v22, v22, v8
  v_mul_f32 v23, v23, v8
  v_cvt_pk_bf16_f32 v16, v16, v17
  v_cvt_pk_bf16_f32 v17, v18, v19
  v_cvt_pk_bf16_f32 v18, v20, v21
  v_cvt_pk_bf16_f32 v19, v22, v23
  buffer_store_dwordx4 v[16:19], v2, s[12:15], s30 offen sc1
  s_waitcnt vmcnt(0)
arr3w:
  s_barrier
  s_cmp_lg_u32 s4, 0
  s_cbranch_scc1 arr3
  s_mov_b64 exec, 1
  v_mov_b32 v5, 30965760
  v_mov_b32 v6, s60
  buffer_store_dword v6, v5, s[12:15], s5 offen sc1
  s_mov_b64 exec, -1
arr3:
  s_add_u32 s27, s2, s4
  s_cmp_lg_u32 s27, 0
  s_cbranch_scc1 p1_nn
  v_mov_b32 v5, 32768
  v_mov_b32 v6, s60
  s_mov_b64 exec, 1
  buffer_store_dword v6, v5, s[12:15], 0 offen sc1
  s_mov_b64 exec, -1
p1_nn:
  v_lshlrev_b32 v7, 10, v3
  v_lshl_add_u32 v7, v4, 4, v7
  s_lshl_b32 s43, s25, 15
  s_lshl_b32 s27, s11, 7
  s_add_u32 s43, s43, s27
  s_lshl_b32 s27, s26, 5
  s_add_u32 s43, s43, s27
  v_lshlrev_b32 v12, 4, v4
  s_lshl_b32 s39, s11, 8
  s_lshl_b32 s27, s26, 6
  s_add_u32 s39, s39, s27
  s_add_u32 s28, s39, 4096
  s_add_u32 s29, s39, 8192
  buffer_load_dwordx4 v[8:11], v7, s[16:19], s43 offen
  buffer_load_dwordx4 v[16:19], v12, s[12:15], s28 offen sc1
  buffer_load_dwordx4 v[24:27], v12, s[12:15], s29 offen sc1
  buffer_load_dwordx4 v[20:23], v12, s[12:15], s28 offen offset:32 sc1
  buffer_load_dwordx4 v[28:31], v12, s[12:15], s29 offen offset:32 sc1
  s_cmp_ge_u32 s34, 112
  s_cbranch_scc1 uv_a
  s_cmp_lt_u32 s4, 4
  s_cbranch_scc1 uv_a
  s_lshl_b32 s28, s34, 15
  s_lshl_b32 s27, s7, 13
  s_add_u32 s28, s28, s27
  s_add_u32 s28, s28, 2359296
  v_and_b32 v13, 1, v1
  v_lshlrev_b32 v13, 10, v13
  v_sub_u32 v13, 158720, v13
  v_lshl_add_u32 v13, v4, 4, v13
  s_lshl_b32 s27, s7, 8
  v_add_u32 v13, s27, v13
  s_mov_b32 m0, 157696
  s_mov_b32 s27, 19456
  buffer_load_dwordx4 v2, s[12:15], s27 offen sc1 lds
  s_mov_b32 m0, 158720
  s_mov_b32 s27, 20480
  buffer_load_dwordx4 v2, s[12:15], s27 offen sc1 lds
  s_add_u32 s27, s28, 0
  buffer_load_dwordx4 v[128:131], v2, s[12:15], s27 offen sc1
  buffer_load_dwordx4 v[132:135], v2, s[12:15], s27 offen offset:1024 sc1
  buffer_load_dwordx4 v[136:139], v2, s[12:15], s27 offen offset:2048 sc1
  buffer_load_dwordx4 v[140:143], v2, s[12:15], s27 offen offset:3072 sc1
  s_add_u32 s27, s28, 4096
  buffer_load_dwordx4 v[144:147], v2, s[12:15], s27 offen sc1
  buffer_load_dwordx4 v[148:151], v2, s[12:15], s27 offen offset:1024 sc1
  buffer_load_dwordx4 v[152:155], v2, s[12:15], s27 offen offset:2048 sc1
  buffer_load_dwordx4 v[156:159], v2, s[12:15], s27 offen offset:3072 sc1
  s_waitcnt vmcnt(8)
  ds_read_b128 v[160:163], v13 offset:0
  ds_read_b128 v[164:167], v13 offset:32
  ds_read_b128 v[168:171], v13 offset:64
  ds_read_b128 v[172:175], v13 offset:96
  ds_read_b128 v[176:179], v13 offset:128
  ds_read_b128 v[180:183], v13 offset:160
  ds_read_b128 v[184:187], v13 offset:192
  ds_read_b128 v[188:191], v13 offset:224
  v_lshlrev_b32 v13, 7, v3
  v_lshl_add_u32 v13, v4, 4, v13
  s_lshl_b32 s27, s7, 8
  s_add_u32 s27, s27, 155648
  v_add_u32 v13, s27, v13
  s_waitcnt vmcnt(0)
  s_waitcnt lgkmcnt(0)
  v_mfma_f32_32x32x16_bf16 v[192:207], v[128:131], v[160:163], 0
  v_mfma_f32_32x32x16_bf16 v[192:207], v[132:135], v[164:167], v[192:207]
  v_mfma_f32_32x32x16_bf16 v[192:207], v[136:139], v[168:171], v[192:207]
  v_mfma_f32_32x32x16_bf16 v[192:207], v[140:143], v[172:175], v[192:207]
  v_mfma_f32_32x32x16_bf16 v[192:207], v[144:147], v[176:179], v[192:207]
  v_mfma_f32_32x32x16_bf16 v[192:207], v[148:151], v[180:183], v[192:207]
  v_mfma_f32_32x32x16_bf16 v[192:207], v[152:155], v[184:187], v[192:207]
  v_mfma_f32_32x32x16_bf16 v[192:207], v[156:159], v[188:191], v[192:207]
  s_nop 7
  s_nop 3
  s_mov_b32 exec_lo, 3
  s_mov_b32 exec_hi, 3
  ds_write_b128 v13, v[192:195] offset:0
  ds_write_b128 v13, v[196:199] offset:32
  ds_write_b128 v13, v[200:203] offset:64
  ds_write_b128 v13, v[204:207] offset:96
  s_mov_b64 exec, -1
uv_a:
  s_waitcnt lgkmcnt(0)
  s_lshl_b32 s28, s25, 15
  s_lshl_b32 s27, s26, 13
  s_add_u32 s28, s28, s27
  s_add_u32 s28, s28, 16777216
  s_cmp_lg_u32 s4, 3
  s_cbranch_scc1 pol4e
  s_mov_b32 s50, 0x40000
  s_lshl_b32 s27, s51, 11
  s_add_u32 s27, s27, 30965760
  v_and_b32 v5, 15, v1
  v_lshlrev_b32 v5, 7, v5
  v_add_u32 v5, s27, v5
pol4:
  buffer_load_dword v6, v5, s[12:15], 0 offen sc1
  s_waitcnt vmcnt(0)
  v_cmp_ne_u32 vcc, s60, v6
  s_cbranch_vccz pol4e
  s_sub_u32 s50, s50, 1
  s_cbranch_scc0 pol4
pol4e:
  s_barrier
  s_add_u32 s27, s28, 0
  buffer_load_dwordx4 v[112:115], v2, s[12:15], s27 offen sc1
  buffer_load_dwordx4 v[116:119], v2, s[12:15], s27 offen offset:1024 sc1
  buffer_load_dwordx4 v[120:123], v2, s[12:15], s27 offen offset:2048 sc1
  buffer_load_dwordx4 v[124:127], v2, s[12:15], s27 offen offset:3072 sc1
  s_add_u32 s27, s28, 4096
  buffer_load_dwordx4 v[128:131], v2, s[12:15], s27 offen sc1
  buffer_load_dwordx4 v[132:135], v2, s[12:15], s27 offen offset:1024 sc1
  buffer_load_dwordx4 v[136:139], v2, s[12:15], s27 offen offset:2048 sc1
  buffer_load_dwordx4 v[140:143], v2, s[12:15], s27 offen offset:3072 sc1
  s_cmp_ge_u32 s34, 112
  s_cbranch_scc1 uv_b
  s_cmp_lg_u32 s4, 4
  s_cbranch_scc1 uv_b
  v_lshlrev_b32 v13, 2, v3
  v_add_u32 v13, 155648, v13
  ds_read_b32 v176, v13 offset:0
  ds_read_b32 v177, v13 offset:128
  ds_read_b32 v178, v13 offset:256
  ds_read_b32 v179, v13 offset:384
  ds_read_b32 v180, v13 offset:512
  ds_read_b32 v181, v13 offset:640
  ds_read_b32 v182, v13 offset:768
  ds_read_b32 v183, v13 offset:896
  s_waitcnt lgkmcnt(0)
  s_barrier
  v_add_f32 v176, v176, v178
  v_add_f32 v177, v177, v179
  v_add_f32 v176, v176, v180
  v_add_f32 v177, v177, v181
  v_add_f32 v176, v176, v182
  v_add_f32 v177, v177, v183
  v_and_b32 v178, 0xffff0000, v176
  v_sub_f32 v176, v176, v178
  v_and_b32 v179, 0xffff0000, v176
  v_sub_f32 v180, v176, v179
  v_and_b32 v181, 0xffff0000, v177
  v_sub_f32 v177, v177, v181
  v_and_b32 v182, 0xffff0000, v177
  v_sub_f32 v183, v177, v182
  v_cvt_pk_bf16_f32 v184, v178, v179
  v_cvt_pk_bf16_f32 v185, v180, v181
  v_cvt_pk_bf16_f32 v186, v182, v183
  v_mov_b32 v187, 0
  s_lshl_b32 s27, s34, 10
  s_add_u32 s27, s27, 30670848
  buffer_store_dwordx4 v[184:187], v2, s[12:15], s27 offen sc1
  s_waitcnt vmcnt(1)
  s_branch uv_c
uv_b:
  s_barrier
uv_c:
  s_waitcnt vmcnt(7)
  v_mfma_f32_32x32x16_bf16 v[144:159], v[48:51], v[112:115], 0
  v_mfma_f32_32x32x16_bf16 v[160:175], v[52:55], v[112:115], 0
  s_waitcnt vmcnt(6)
  v_mfma_f32_32x32x16_bf16 v[144:159], v[56:59], v[116:119], v[144:159]
  v_mfma_f32_32x32x16_bf16 v[160:175], v[60:63], v[116:119], v[160:175]
  s_waitcnt vmcnt(5)
  v_mfma_f32_32x32x16_bf16 v[144:159], v[64:67], v[120:123], v[144:159]
  v_mfma_f32_32x32x16_bf16 v[160:175], v[68:71], v[120:123], v[160:175]
  s_waitcnt vmcnt(4)
  v_mfma_f32_32x32x16_bf16 v[144:159], v[72:75], v[124:127], v[144:159]
  v_mfma_f32_32x32x16_bf16 v[160:175], v[76:79], v[124:127], v[160:175]
  s_waitcnt vmcnt(3)
  v_mfma_f32_32x32x16_bf16 v[144:159], v[80:83], v[128:131], v[144:159]
  v_mfma_f32_32x32x16_bf16 v[160:175], v[84:87], v[128:131], v[160:175]
  s_waitcnt vmcnt(2)
  v_mfma_f32_32x32x16_bf16 v[144:159], v[88:91], v[132:135], v[144:159]
  v_mfma_f32_32x32x16_bf16 v[160:175], v[92:95], v[132:135], v[160:175]
  s_waitcnt vmcnt(1)
  v_mfma_f32_32x32x16_bf16 v[144:159], v[96:99], v[136:139], v[144:159]
  v_mfma_f32_32x32x16_bf16 v[160:175], v[100:103], v[136:139], v[160:175]
  s_waitcnt vmcnt(0)
  v_mfma_f32_32x32x16_bf16 v[144:159], v[104:107], v[140:143], v[144:159]
  v_mfma_f32_32x32x16_bf16 v[160:175], v[108:111], v[140:143], v[160:175]
  s_and_b32 s27, s4, 1
  s_lshl_b32 s27, s27, 13
  s_lshl_b32 s28, s26, 11
  s_add_u32 s28, s28, s27
  s_add_u32 s28, s28, 98304
  v_add_u32 v13, s28, v2
  s_lshl_b32 s28, s4, 13
  s_add_u32 s28, s28, 98304
  v_permlane32_swap_b32 v8, v10
  v_permlane32_swap_b32 v9, v11
  s_nop 4
  ds_write_b128 v13, v[144:147] offset:0
  ds_write_b128 v13, v[148:151] offset:1024
  ds_write_b128 v13, v[152:155] offset:16384
  ds_write_b128 v13, v[156:159] offset:17408
  ds_write_b128 v13, v[160:163] offset:32768
  ds_write_b128 v13, v[164:167] offset:33792
  ds_write_b128 v13, v[168:171] offset:49152
  ds_write_b128 v13, v[172:175] offset:50176
  v_add_u32 v13, s28, v2
  s_waitcnt lgkmcnt(0)
  s_barrier
  ds_read_b128 v[144:147], v13 offset:0
  ds_read_b128 v[148:151], v13 offset:1024
  ds_read_b128 v[152:155], v13 offset:2048
  ds_read_b128 v[156:159], v13 offset:3072
  ds_read_b128 v[160:163], v13 offset:4096
  ds_read_b128 v[164:167], v13 offset:5120
  ds_read_b128 v[168:171], v13 offset:6144
  ds_read_b128 v[172:175], v13 offset:7168
  s_waitcnt lgkmcnt(4)
  v_pk_add_f32 v[144:145], v[144:145], v[152:153]
  v_pk_add_f32 v[146:147], v[146:147], v[154:155]
  v_pk_add_f32 v[148:149], v[148:149], v[156:157]
  v_pk_add_f32 v[150:151], v[150:151], v[158:159]
  s_waitcnt lgkmcnt(2)
  v_pk_add_f32 v[144:145], v[144:145], v[160:161]
  v_pk_add_f32 v[146:147], v[146:147], v[162:163]
  v_pk_add_f32 v[148:149], v[148:149], v[164:165]
  v_pk_add_f32 v[150:151], v[150:151], v[166:167]
  s_waitcnt lgkmcnt(0)
  v_pk_add_f32 v[144:145], v[144:145], v[168:169]
  v_pk_add_f32 v[146:147], v[146:147], v[170:171]
  v_pk_add_f32 v[148:149], v[148:149], v[172:173]
  v_pk_add_f32 v[150:151], v[150:151], v[174:175]
  v_mov_b32 v36, 0
  v_mov_b32 v37, 0
  v_lshlrev_b32 v32, 16, v8
  v_and_b32 v33, 0xffff0000, v8
  v_fma_f32 v32, v144, v16, v32
  v_fma_f32 v33, v145, v17, v33
  v_cvt_pk_bf16_f32 v8, v32, v33
  v_lshlrev_b32 v32, 16, v8
  v_and_b32 v33, 0xffff0000, v8
  v_add_f32 v36, v36, v32
  v_fmac_f32 v37, v32, v32
  v_add_f32 v36, v36, v33
  v_fmac_f32 v37, v33, v33
  v_mul_f32 v32, v32, v24
  v_mul_f32 v33, v33, v25
  v_cvt_pk_bf16_f32 v40, v32, v33
  v_lshlrev_b32 v32, 16, v9
  v_and_b32 v33, 0xffff0000, v9
  v_fma_f32 v32, v146, v18, v32
  v_fma_f32 v33, v147, v19, v33
  v_cvt_pk_bf16_f32 v9, v32, v33
  v_lshlrev_b32 v32, 16, v9
  v_and_b32 v33, 0xffff0000, v9
  v_add_f32 v36, v36, v32
  v_fmac_f32 v37, v32, v32
  v_add_f32 v36, v36, v33
  v_fmac_f32 v37, v33, v33
  v_mul_f32 v32, v32, v26
  v_mul_f32 v33, v33, v27
  v_cvt_pk_bf16_f32 v41, v32, v33
  v_lshlrev_b32 v32, 16, v10
  v_and_b32 v33, 0xffff0000, v10
  v_fma_f32 v32, v148, v20, v32
  v_fma_f32 v33, v149, v21, v33
  v_cvt_pk_bf16_f32 v10, v32, v33
  v_lshlrev_b32 v32, 16, v10
  v_and_b32 v33, 0xffff0000, v10
  v_add_f32 v36, v36, v32
  v_fmac_f32 v37, v32, v32
  v_add_f32 v36, v36, v33
  v_fmac_f32 v37, v33, v33
  v_mul_f32 v32, v32, v28
  v_mul_f32 v33, v33, v29
  v_cvt_pk_bf16_f32 v42, v32, v33
  v_lshlrev_b32 v32, 16, v11
  v_and_b32 v33, 0xffff0000, v11
  v_fma_f32 v32, v150, v22, v32
  v_fma_f32 v33, v151, v23, v33
  v_cvt_pk_bf16_f32 v11, v32, v33
  v_lshlrev_b32 v32, 16, v11
  v_and_b32 v33, 0xffff0000, v11
  v_add_f32 v36, v36, v32
  v_fmac_f32 v37, v32, v32
  v_add_f32 v36, v36, v33
  v_fmac_f32 v37, v33, v33
  v_mul_f32 v32, v32, v30
  v_mul_f32 v33, v33, v31
  v_cvt_pk_bf16_f32 v43, v32, v33
  s_lshl_b32 s28, s25, 15
  s_lshl_b32 s27, s11, 12
  s_add_u32 s28, s28, s27
  s_lshl_b32 s27, s26, 10
  s_add_u32 s28, s28, s27
  s_add_u32 s28, s28, 20971520
  v_permlane32_swap_b32 v40, v42
  v_permlane32_swap_b32 v41, v43
  buffer_store_dwordx4 v[40:43], v2, s[12:15], s28 offen sc1
  ds_write_b64 v13, v[36:37] offset:0
  s_waitcnt lgkmcnt(0)
  s_barrier
  s_cmp_ge_u32 s4, 2
  s_cbranch_scc1 p3_b
  ds_read_b64 v[32:33], v13 offset:0
  ds_read_b64 v[34:35], v13 offset:16384
  ds_read_b64 v[36:37], v13 offset:32768
  ds_read_b64 v[38:39], v13 offset:49152
  s_waitcnt lgkmcnt(0)
  v_add_f32 v32, v32, v34
  v_add_f32 v33, v33, v35
  v_add_f32 v36, v36, v38
  v_add_f32 v37, v37, v39
  v_add_f32 v32, v32, v36
  v_add_f32 v33, v33, v37
  v_mov_b32 v34, v32
  v_mov_b32 v35, v33
  s_lshl_b32 s28, s25, 11
  s_lshl_b32 s27, s11, 8
  v_permlane32_swap_b32 v34, v32
  v_permlane32_swap_b32 v35, v33
  s_add_u32 s28, s28, s27
  s_add_u32 s28, s28, 30408704
  v_add_f32 v32, v32, v34
  v_add_f32 v33, v33, v35
  v_lshlrev_b32 v34, 3, v3
  s_mov_b32 exec_hi, 0
  buffer_store_dwordx2 v[32:33], v34, s[12:15], s28 offen sc1
  s_mov_b32 exec_hi, -1
p3_b:
  s_waitcnt vmcnt(0)
arr5w:
  s_barrier
  s_cmp_lg_u32 s4, 0
  s_cbranch_scc1 arr5
  s_mov_b64 exec, 1
  v_mov_b32 v5, 30998528
  v_mov_b32 v6, s60
  buffer_store_dword v6, v5, s[12:15], s6 offen sc1
  s_mov_b64 exec, -1
arr5:
  s_mul_i32 s29, s4, 12288
  s_add_u32 s28, s41, s29
  s_add_u32 m0, s29, 6144
  s_add_u32 s27, s28, 6144
  buffer_load_dwordx4 v2, s[12:15], s27 offen sc1 lds
  s_add_u32 m0, s29, 7168
  s_add_u32 s27, s28, 7168
  buffer_load_dwordx4 v2, s[12:15], s27 offen sc1 lds
  s_add_u32 m0, s29, 8192
  s_add_u32 s27, s28, 8192
  buffer_load_dwordx4 v2, s[12:15], s27 offen sc1 lds
  s_add_u32 m0, s29, 9216
  s_add_u32 s27, s28, 9216
  buffer_load_dwordx4 v2, s[12:15], s27 offen sc1 lds
  s_add_u32 m0, s29, 10240
  s_add_u32 s27, s28, 10240
  buffer_load_dwordx4 v2, s[12:15], s27 offen sc1 lds
  s_add_u32 m0, s29, 11264
  s_add_u32 s27, s28, 11264
  buffer_load_dwordx4 v2, s[12:15], s27 offen sc1 lds
  s_cmp_lt_u32 s4, 4
  s_cbranch_scc1 p4_a
  s_lshl_b32 s29, s7, 12
  s_add_u32 s28, s41, s29
  s_sub_u32 s32, s42, 114688
  s_add_u32 m0, s29, 98304
  s_add_u32 s27, s28, 98304
  buffer_load_dwordx4 v2, s[12:15], s27 offen sc1 lds
  s_add_u32 m0, s29, 99328
  s_add_u32 s27, s28, 99328
  buffer_load_dwordx4 v2, s[12:15], s27 offen sc1 lds
  s_add_u32 m0, s29, 100352
  s_add_u32 s27, s28, 100352
  buffer_load_dwordx4 v2, s[12:15], s27 offen sc1 lds
  s_add_u32 m0, s29, 101376
  s_add_u32 s27, s28, 101376
  buffer_load_dwordx4 v2, s[12:15], s27 offen sc1 lds
  s_add_u32 m0, s29, 114688
  s_add_u32 s27, s28, 114688
  buffer_load_dwordx4 v2, s[12:15], s27 offen sc1 lds
  s_add_u32 m0, s29, 115712
  s_add_u32 s27, s28, 115712
  buffer_load_dwordx4 v2, s[12:15], s27 offen sc1 lds
  s_add_u32 m0, s29, 116736
  s_add_u32 s27, s28, 116736
  buffer_load_dwordx4 v2, s[12:15], s27 offen sc1 lds
  s_add_u32 m0, s29, 117760
  s_add_u32 s27, s28, 117760
  buffer_load_dwordx4 v2, s[12:15], s27 offen sc1 lds
  s_add_u32 m0, s29, 131072
  s_add_u32 s27, s28, 131072
  buffer_load_dwordx4 v2, s[12:15], s27 offen sc1 lds
  s_add_u32 m0, s29, 132096
  s_add_u32 s27, s28, 132096
  buffer_load_dwordx4 v2, s[12:15], s27 offen sc1 lds
  s_add_u32 m0, s29, 133120
  s_add_u32 s27, s28, 133120
  buffer_load_dwordx4 v2, s[12:15], s27 offen sc1 lds
  s_add_u32 m0, s29, 134144
  s_add_u32 s27, s28, 134144
  buffer_load_dwordx4 v2, s[12:15], s27 offen sc1 lds
  s_waitcnt vmcnt(12)
  s_branch p4_b
p4_a:
  s_waitcnt vmcnt(0)
p4_b:
  s_cmp_lg_u32 s4, 3
  s_cbranch_scc1 pol6e
  s_mov_b32 s50, 0x40000
  s_lshl_b32 s27, s44, 11
  s_add_u32 s27, s27, 30998528
  v_and_b32 v5, 15, v1
  v_lshlrev_b32 v5, 7, v5
  v_add_u32 v5, s27, v5
pol6:
  buffer_load_dword v6, v5, s[12:15], 0 offen sc1
  s_waitcnt vmcnt(0)
  v_cmp_ne_u32 vcc, s60, v6
  s_cbranch_vccz pol6e
  s_sub_u32 s50, s50, 1
  s_cbranch_scc0 pol6
pol6e:
  s_barrier
  s_cmp_ge_u32 s4, 4
  s_cbranch_scc1 p4_L
  s_lshl_b32 s28, s46, 15
  s_add_u32 s28, s28, 20971520
  s_lshl_b32 s29, s46, 11
  s_add_u32 s29, s29, 30408704
  v_lshlrev_b32 v5, 3, v3
  v_lshl_add_u32 v5, v4, 10, v5
  s_add_u32 s27, s28, 0
  buffer_load_dwordx4 v[128:131], v2, s[12:15], s27 offen sc1
  buffer_load_dwordx4 v[132:135], v2, s[12:15], s27 offen offset:1024 sc1
  buffer_load_dwordx4 v[136:139], v2, s[12:15], s27 offen offset:2048 sc1
  buffer_load_dwordx4 v[140:143], v2, s[12:15], s27 offen offset:3072 sc1
  buffer_load_dwordx2 v[116:117], v5, s[12:15], s29 offen sc1
  buffer_load_dwordx2 v[118:119], v5, s[12:15], s29 offen offset:256 sc1
  buffer_load_dwordx2 v[120:121], v5, s[12:15], s29 offen offset:512 sc1
  buffer_load_dwordx2 v[122:123], v5, s[12:15], s29 offen offset:768 sc1
  s_add_u32 s29, s28, 4096
  buffer_load_dwordx4 v[144:147], v2, s[12:15], s29 offen sc1
  buffer_load_dwordx4 v[148:151], v2, s[12:15], s29 offen offset:1024 sc1
  buffer_load_dwordx4 v[152:155], v2, s[12:15], s29 offen offset:2048 sc1
  buffer_load_dwordx4 v[156:159], v2, s[12:15], s29 offen offset:3072 sc1
  s_add_u32 s29, s28, 8192
  buffer_load_dwordx4 v[160:163], v2, s[12:15], s29 offen sc1
  buffer_load_dwordx4 v[164:167], v2, s[12:15], s29 offen offset:1024 sc1
  buffer_load_dwordx4 v[168:171], v2, s[12:15], s29 offen offset:2048 sc1
  buffer_load_dwordx4 v[172:175], v2, s[12:15], s29 offen offset:3072 sc1
  s_add_u32 s29, s28, 12288
  buffer_load_dwordx4 v[176:179], v2, s[12:15], s29 offen sc1
  buffer_load_dwordx4 v[180:183], v2, s[12:15], s29 offen offset:1024 sc1
  buffer_load_dwordx4 v[184:187], v2, s[12:15], s29 offen offset:2048 sc1
  buffer_load_dwordx4 v[188:191], v2, s[12:15], s29 offen offset:3072 sc1
  s_add_u32 s29, s28, 16384
  buffer_load_dwordx4 v[192:195], v2, s[12:15], s29 offen sc1
  buffer_load_dwordx4 v[196:199], v2, s[12:15], s29 offen offset:1024 sc1
  buffer_load_dwordx4 v[200:203], v2, s[12:15], s29 offen offset:2048 sc1
  buffer_load_dwordx4 v[204:207], v2, s[12:15], s29 offen offset:3072 sc1
  s_add_u32 s29, s28, 20480
  buffer_load_dwordx4 v[208:211], v2, s[12:15], s29 offen sc1
  buffer_load_dwordx4 v[212:215], v2, s[12:15], s29 offen offset:1024 sc1
  buffer_load_dwordx4 v[216:219], v2, s[12:15], s29 offen offset:2048 sc1
  buffer_load_dwordx4 v[220:223], v2, s[12:15], s29 offen offset:3072 sc1
  s_mul_i32 s30, s46, 114688
  s_mul_i32 s27, s45, 7168
  s_add_u32 s30, s30, s27
  s_add_u32 s30, s30, 23068672
  s_add_u32 s31, s30, 4096
  ds_read_b128 v[80:83], v2 offset:0
  ds_read_b128 v[84:87], v2 offset:32768
  ds_read_b128 v[88:91], v2 offset:1024
  ds_read_b128 v[92:95], v2 offset:33792
  ds_read_b128 v[96:99], v2 offset:2048
  ds_read_b128 v[100:103], v2 offset:34816
  ds_read_b128 v[104:107], v2 offset:3072
  s_waitcnt vmcnt(27)
  s_waitcnt lgkmcnt(4)
  v_mfma_f32_32x32x16_bf16 v[16:31], v[80:83], v[128:131], 0
  s_add_u32 s29, s28, 24576
  buffer_load_dwordx4 v[224:227], v2, s[12:15], s29 offen sc1
  ds_read_b128 v[108:111], v2 offset:35840
  v_mfma_f32_32x32x16_bf16 v[32:47], v[84:87], v[128:131], 0
  ds_read_b128 v[80:83], v2 offset:4096
  s_waitcnt vmcnt(27)
  v_mfma_f32_32x32x16_bf16 v[16:31], v[88:91], v[132:135], v[16:31]
  buffer_load_dwordx4 v[228:231], v2, s[12:15], s29 offen offset:1024 sc1
  ds_read_b128 v[84:87], v2 offset:36864
  s_waitcnt lgkmcnt(4)
  v_mfma_f32_32x32x16_bf16 v[32:47], v[92:95], v[132:135], v[32:47]
  ds_read_b128 v[88:91], v2 offset:5120
  s_waitcnt vmcnt(27)
  v_mfma_f32_32x32x16_bf16 v[16:31], v[96:99], v[136:139], v[16:31]
  buffer_load_dwordx4 v[232:235], v2, s[12:15], s29 offen offset:2048 sc1
  ds_read_b128 v[92:95], v2 offset:37888
  v_mfma_f32_32x32x16_bf16 v[32:47], v[100:103], v[136:139], v[32:47]
  ds_read_b128 v[96:99], v2 offset:6144
  s_waitcnt vmcnt(27)
  s_waitcnt lgkmcnt(4)
  v_mfma_f32_32x32x16_bf16 v[16:31], v[104:107], v[140:143], v[16:31]
  buffer_load_dwordx4 v[236:239], v2, s[12:15], s29 offen offset:3072 sc1
  ds_read_b128 v[100:103], v2 offset:38912
  v_mfma_f32_32x32x16_bf16 v[32:47], v[108:111], v[140:143], v[32:47]
  ds_read_b128 v[104:107], v2 offset:7168
  s_waitcnt vmcnt(23)
  v_mfma_f32_32x32x16_bf16 v[16:31], v[80:83], v[144:147], v[16:31]
  s_add_u32 s29, s28, 28672
  buffer_load_dwordx4 v[240:243], v2, s[12:15], s29 offen sc1
  ds_read_b128 v[108:111], v2 offset:39936
  s_waitcnt lgkmcnt(4)
  v_mfma_f32_32x32x16_bf16 v[32:47], v[84:87], v[144:147], v[32:47]
  ds_read_b128 v[80:83], v2 offset:8192
  s_waitcnt vmcnt(23)
  v_mfma_f32_32x32x16_bf16 v[16:31], v[88:91], v[148:151], v[16:31]
  buffer_load_dwordx4 v[244:247], v2, s[12:15], s29 offen offset:1024 sc1
  v_add_f32 v116, v116, v118
  v_add_f32 v117, v117, v119
  v_add_f32 v120, v120, v122
  v_add_f32 v121, v121, v123
  v_add_f32 v116, v116, v120
  v_add_f32 v117, v117, v121
  v_mov_b32 v118, v116
  v_mov_b32 v119, v117
  s_nop 1
  v_permlane32_swap_b32 v118, v116
  v_permlane32_swap_b32 v119, v117
  s_nop 1
  v_add_f32 v116, v116, v118
  v_add_f32 v117, v117, v119
  v_mul_f32 v116, 0x3b000000, v116
  v_mul_f32 v118, v116, v116
  v_mul_f32 v117, 0x3b000000, v117
  v_sub_f32 v117, v117, v118
  v_max_f32 v117, 0, v117
  v_cvt_pk_bf16_f32 v116, v116, v116
  v_and_b32 v116, 0xffff0000, v116
  v_cvt_pk_bf16_f32 v117, v117, v117
  v_and_b32 v117, 0xffff0000, v117
  v_add_f32 v117, 0x3727c5ac, v117
  v_cvt_pk_bf16_f32 v117, v117, v117
  v_and_b32 v117, 0xffff0000, v117
  v_sqrt_f32 v117, v117
  s_nop 0
  v_cvt_pk_bf16_f32 v117, v117, v117
  v_and_b32 v117, 0xffff0000, v117
  v_mov_b32 v119, v117
  v_rcp_f32 v117, v117
  s_nop 0
  v_sub_f32 v116, 0, v116
  v_mul_f32 v120, 0xbfb8aa3b, v117
  v_mov_b32 v122, v119
  v_mov_b32 v112, 0
  v_mov_b32 v113, 0
  v_mov_b32 v114, 0
  v_mov_b32 v115, 0
  s_mov_b32 exec_hi, 0
  v_cvt_pk_bf16_f32 v112, v116, v116
  v_cvt_pk_bf16_f32 v113, v116, v119
  v_cvt_pk_bf16_f32 v114, v119, v119
  s_mov_b32 exec_hi, -1
  ds_read_b128 v[84:87], v2 offset:40960
  v_mfma_f32_32x32x16_bf16 v[32:47], v[92:95], v[148:151], v[32:47]
  ds_read_b128 v[88:91], v2 offset:9216
  s_waitcnt vmcnt(23)
  s_waitcnt lgkmcnt(4)
  v_mfma_f32_32x32x16_bf16 v[16:31], v[96:99], v[152:155], v[16:31]
  buffer_load_dwordx4 v[248:251], v2, s[12:15], s29 offen offset:2048 sc1
  ds_read_b128 v[92:95], v2 offset:41984
  v_mfma_f32_32x32x16_bf16 v[32:47], v[100:103], v[152:155], v[32:47]
  ds_read_b128 v[96:99], v2 offset:10240
  s_waitcnt vmcnt(23)
  v_mfma_f32_32x32x16_bf16 v[16:31], v[104:107], v[156:159], v[16:31]
  buffer_load_dwordx4 v[252:255], v2, s[12:15], s29 offen offset:3072 sc1
  ds_read_b128 v[100:103], v2 offset:43008
  s_waitcnt lgkmcnt(4)
  v_mfma_f32_32x32x16_bf16 v[32:47], v[108:111], v[156:159], v[32:47]
  ds_read_b128 v[104:107], v2 offset:11264
  s_waitcnt vmcnt(23)
  v_mfma_f32_32x32x16_bf16 v[16:31], v[80:83], v[160:163], v[16:31]
  ds_read_b128 v[108:111], v2 offset:44032
  v_mfma_f32_32x32x16_bf16 v[32:47], v[84:87], v[160:163], v[32:47]
  ds_read_b128 v[80:83], v2 offset:12288
  s_waitcnt vmcnt(22)
  s_waitcnt lgkmcnt(4)
  v_mfma_f32_32x32x16_bf16 v[16:31], v[88:91], v[164:167], v[16:31]
  ds_read_b128 v[84:87], v2 offset:45056
  v_mfma_f32_32x32x16_bf16 v[32:47], v[92:95], v[164:167], v[32:47]
  ds_read_b128 v[88:91], v2 offset:13312
  s_waitcnt vmcnt(21)
  v_mfma_f32_32x32x16_bf16 v[16:31], v[96:99], v[168:171], v[16:31]
  ds_read_b128 v[92:95], v2 offset:46080
  s_waitcnt lgkmcnt(4)
  v_mfma_f32_32x32x16_bf16 v[32:47], v[100:103], v[168:171], v[32:47]
  ds_read_b128 v[96:99], v2 offset:14336
  s_waitcnt vmcnt(20)
  v_mfma_f32_32x32x16_bf16 v[16:31], v[104:107], v[172:175], v[16:31]
  ds_read_b128 v[100:103], v2 offset:47104
  v_mfma_f32_32x32x16_bf16 v[32:47], v[108:111], v[172:175], v[32:47]
  ds_read_b128 v[104:107], v2 offset:15360
  s_waitcnt vmcnt(19)
  s_waitcnt lgkmcnt(4)
  v_mfma_f32_32x32x16_bf16 v[16:31], v[80:83], v[176:179], v[16:31]
  ds_read_b128 v[108:111], v2 offset:48128
  v_mfma_f32_32x32x16_bf16 v[32:47], v[84:87], v[176:179], v[32:47]
  ds_read_b128 v[80:83], v2 offset:16384
  s_waitcnt vmcnt(18)
  v_mfma_f32_32x32x16_bf16 v[16:31], v[88:91], v[180:183], v[16:31]
  ds_read_b128 v[84:87], v2 offset:49152
  s_waitcnt lgkmcnt(4)
  v_mfma_f32_32x32x16_bf16 v[32:47], v[92:95], v[180:183], v[32:47]
  ds_read_b128 v[88:91], v2 offset:17408
  s_waitcnt vmcnt(17)
  v_mfma_f32_32x32x16_bf16 v[16:31], v[96:99], v[184:187], v[16:31]
  ds_read_b128 v[92:95], v2 offset:50176
  v_mfma_f32_32x32x16_bf16 v[32:47], v[100:103], v[184:187], v[32:47]
  ds_read_b128 v[96:99], v2 offset:18432
  s_waitcnt vmcnt(16)
  s_waitcnt lgkmcnt(4)
  v_mfma_f32_32x32x16_bf16 v[16:31], v[104:107], v[188:191], v[16:31]
  ds_read_b128 v[100:103], v2 offset:51200
  v_mfma_f32_32x32x16_bf16 v[32:47], v[108:111], v[188:191], v[32:47]
  ds_read_b128 v[104:107], v2 offset:19456
  s_waitcnt vmcnt(15)
  v_mfma_f32_32x32x16_bf16 v[16:31], v[80:83], v[192:195], v[16:31]
  ds_read_b128 v[108:111], v2 offset:52224
  s_waitcnt lgkmcnt(4)
  v_mfma_f32_32x32x16_bf16 v[32:47], v[84:87], v[192:195], v[32:47]
  ds_read_b128 v[80:83], v2 offset:20480
  s_waitcnt vmcnt(14)
  v_mfma_f32_32x32x16_bf16 v[16:31], v[88:91], v[196:199], v[16:31]
  ds_read_b128 v[84:87], v2 offset:53248
  v_mfma_f32_32x32x16_bf16 v[32:47], v[92:95], v[196:199], v[32:47]
  ds_read_b128 v[88:91], v2 offset:21504
  s_waitcnt vmcnt(13)
  s_waitcnt lgkmcnt(4)
  v_mfma_f32_32x32x16_bf16 v[16:31], v[96:99], v[200:203], v[16:31]
  ds_read_b128 v[92:95], v2 offset:54272
  v_mfma_f32_32x32x16_bf16 v[32:47], v[100:103], v[200:203], v[32:47]
  ds_read_b128 v[96:99], v2 offset:22528
  s_waitcnt vmcnt(12)
  v_mfma_f32_32x32x16_bf16 v[16:31], v[104:107], v[204:207], v[16:31]
  ds_read_b128 v[100:103], v2 offset:55296
  s_waitcnt lgkmcnt(4)
  v_mfma_f32_32x32x16_bf16 v[32:47], v[108:111], v[204:207], v[32:47]
  ds_read_b128 v[104:107], v2 offset:23552
  s_waitcnt vmcnt(11)
  v_mfma_f32_32x32x16_bf16 v[16:31], v[80:83], v[208:211], v[16:31]
  ds_read_b128 v[108:111], v2 offset:56320
  v_mfma_f32_32x32x16_bf16 v[32:47], v[84:87], v[208:211], v[32:47]
  ds_read_b128 v[80:83], v2 offset:24576
  s_waitcnt vmcnt(10)
  s_waitcnt lgkmcnt(4)
  v_mfma_f32_32x32x16_bf16 v[16:31], v[88:91], v[212:215], v[16:31]
  ds_read_b128 v[84:87], v2 offset:57344
  v_mfma_f32_32x32x16_bf16 v[32:47], v[92:95], v[212:215], v[32:47]
  ds_read_b128 v[88:91], v2 offset:25600
  s_waitcnt vmcnt(9)
  v_mfma_f32_32x32x16_bf16 v[16:31], v[96:99], v[216:219], v[16:31]
  ds_read_b128 v[92:95], v2 offset:58368
  s_waitcnt lgkmcnt(4)
  v_mfma_f32_32x32x16_bf16 v[32:47], v[100:103], v[216:219], v[32:47]
  ds_read_b128 v[96:99], v2 offset:26624
  s_waitcnt vmcnt(8)
  v_mfma_f32_32x32x16_bf16 v[16:31], v[104:107], v[220:223], v[16:31]
  ds_read_b128 v[100:103], v2 offset:59392
  v_mfma_f32_32x32x16_bf16 v[32:47], v[108:111], v[220:223], v[32:47]
  ds_read_b128 v[104:107], v2 offset:27648
  s_waitcnt vmcnt(7)
  s_waitcnt lgkmcnt(4)
  v_mfma_f32_32x32x16_bf16 v[16:31], v[80:83], v[224:227], v[16:31]
  ds_read_b128 v[108:111], v2 offset:60416
  v_mfma_f32_32x32x16_bf16 v[32:47], v[84:87], v[224:227], v[32:47]
  ds_read_b128 v[80:83], v2 offset:28672
  s_waitcnt vmcnt(6)
  v_mfma_f32_32x32x16_bf16 v[16:31], v[88:91], v[228:231], v[16:31]
  ds_read_b128 v[84:87], v2 offset:61440
  s_waitcnt lgkmcnt(4)
  v_mfma_f32_32x32x16_bf16 v[32:47], v[92:95], v[228:231], v[32:47]
  ds_read_b128 v[88:91], v2 offset:29696
  s_waitcnt vmcnt(5)
  v_mfma_f32_32x32x16_bf16 v[16:31], v[96:99], v[232:235], v[16:31]
  ds_read_b128 v[92:95], v2 offset:62464
  v_mfma_f32_32x32x16_bf16 v[32:47], v[100:103], v[232:235], v[32:47]
  ds_read_b128 v[96:99], v2 offset:30720
  s_waitcnt vmcnt(4)
  s_waitcnt lgkmcnt(4)
  v_mfma_f32_32x32x16_bf16 v[16:31], v[104:107], v[236:239], v[16:31]
  ds_read_b128 v[100:103], v2 offset:63488
  v_mfma_f32_32x32x16_bf16 v[32:47], v[108:111], v[236:239], v[32:47]
  ds_read_b128 v[104:107], v2 offset:31744
  s_waitcnt vmcnt(3)
  v_mfma_f32_32x32x16_bf16 v[16:31], v[80:83], v[240:243], v[16:31]
  ds_read_b128 v[108:111], v2 offset:64512
  s_waitcnt lgkmcnt(4)
  v_mfma_f32_32x32x16_bf16 v[32:47], v[84:87], v[240:243], v[32:47]
  s_barrier
  ds_read_b128 v[80:83], v15 offset:16384
  s_waitcnt vmcnt(2)
  v_mfma_f32_32x32x16_bf16 v[16:31], v[88:91], v[244:247], v[16:31]
  ds_read_b128 v[84:87], v15 offset:17408
  v_mfma_f32_32x32x16_bf16 v[32:47], v[92:95], v[244:247], v[32:47]
  ds_read_b128 v[88:91], v14 offset:0
  s_waitcnt vmcnt(1)
  s_waitcnt lgkmcnt(4)
  v_mfma_f32_32x32x16_bf16 v[16:31], v[96:99], v[248:251], v[16:31]
  ds_read_b128 v[92:95], v14 offset:1024
  v_mfma_f32_32x32x16_bf16 v[32:47], v[100:103], v[248:251], v[32:47]
  ds_read_b128 v[96:99], v14 offset:2048
  s_waitcnt vmcnt(0)
  v_mfma_f32_32x32x16_bf16 v[16:31], v[104:107], v[252:255], v[16:31]
  ds_read_b128 v[100:103], v14 offset:3072
  s_waitcnt lgkmcnt(4)
  v_mfma_f32_32x32x16_bf16 v[32:47], v[108:111], v[252:255], v[32:47]
  ds_read_b128 v[104:107], v14 offset:4096
  v_mfma_f32_32x32x16_bf16 v[16:31], v[80:83], v[112:115], v[16:31]
  ds_read_b128 v[108:111], v14 offset:5120
  v_mfma_f32_32x32x16_bf16 v[32:47], v[84:87], v[112:115], v[32:47]
  ds_read_b128 v[80:83], v14 offset:6144
  s_waitcnt lgkmcnt(4)
  v_mfma_f32_32x32x16_bf16 v[48:63], v[88:91], v[128:131], 0
  ds_read_b128 v[84:87], v14 offset:7168
  v_mfma_f32_32x32x16_bf16 v[48:63], v[92:95], v[132:135], v[48:63]
  ds_read_b128 v[88:91], v14 offset:8192
  v_mfma_f32_32x32x16_bf16 v[48:63], v[96:99], v[136:139], v[48:63]
  v_mul_f32 v116, v16, v120
  v_mul_f32 v117, v17, v120
  ds_read_b128 v[92:95], v14 offset:9216
  s_waitcnt lgkmcnt(4)
  v_mfma_f32_32x32x16_bf16 v[48:63], v[100:103], v[140:143], v[48:63]
  v_mul_f32 v118, v18, v120
  v_mul_f32 v119, v19, v120
  ds_read_b128 v[96:99], v14 offset:10240
  v_mfma_f32_32x32x16_bf16 v[48:63], v[104:107], v[144:147], v[48:63]
  v_exp_f32 v116, v116
  ds_read_b128 v[100:103], v14 offset:11264
  v_mfma_f32_32x32x16_bf16 v[48:63], v[108:111], v[148:151], v[48:63]
  v_exp_f32 v117, v117
  ds_read_b128 v[104:107], v14 offset:12288
  s_waitcnt lgkmcnt(4)
  v_mfma_f32_32x32x16_bf16 v[48:63], v[80:83], v[152:155], v[48:63]
  v_exp_f32 v118, v118
  ds_read_b128 v[108:111], v14 offset:13312
  v_mfma_f32_32x32x16_bf16 v[48:63], v[84:87], v[156:159], v[48:63]
  v_exp_f32 v119, v119
  ds_read_b128 v[80:83], v14 offset:14336
  v_mfma_f32_32x32x16_bf16 v[48:63], v[88:91], v[160:163], v[48:63]
  v_fma_f32 v116, v116, v122, v122
  v_fma_f32 v117, v117, v122, v122
  ds_read_b128 v[84:87], v14 offset:15360
  s_waitcnt lgkmcnt(4)
  v_mfma_f32_32x32x16_bf16 v[48:63], v[92:95], v[164:167], v[48:63]
  v_fma_f32 v118, v118, v122, v122
  v_fma_f32 v119, v119, v122, v122
  ds_read_b128 v[88:91], v14 offset:16384
  v_mfma_f32_32x32x16_bf16 v[48:63], v[96:99], v[168:171], v[48:63]
  v_rcp_f32 v116, v116
  ds_read_b128 v[92:95], v14 offset:17408
  v_mfma_f32_32x32x16_bf16 v[48:63], v[100:103], v[172:175], v[48:63]
  v_rcp_f32 v117, v117
  ds_read_b128 v[96:99], v14 offset:18432
  s_waitcnt lgkmcnt(4)
  v_mfma_f32_32x32x16_bf16 v[48:63], v[104:107], v[176:179], v[48:63]
  v_rcp_f32 v118, v118
  ds_read_b128 v[100:103], v14 offset:19456
  v_mfma_f32_32x32x16_bf16 v[48:63], v[108:111], v[180:183], v[48:63]
  v_rcp_f32 v119, v119
  ds_read_b128 v[104:107], v14 offset:20480
  v_mfma_f32_32x32x16_bf16 v[48:63], v[80:83], v[184:187], v[48:63]
  v_mul_f32 v116, v116, v24
  v_mul_f32 v117, v117, v25
  ds_read_b128 v[108:111], v14 offset:21504
  s_waitcnt lgkmcnt(4)
  v_mfma_f32_32x32x16_bf16 v[48:63], v[84:87], v[188:191], v[48:63]
  v_mul_f32 v118, v118, v26
  v_mul_f32 v119, v119, v27
  ds_read_b128 v[80:83], v14 offset:22528
  v_mfma_f32_32x32x16_bf16 v[48:63], v[88:91], v[192:195], v[48:63]
  v_cvt_pk_bf16_f32 v124, v116, v117
  v_cvt_pk_bf16_f32 v125, v118, v119
  ds_read_b128 v[84:87], v14 offset:23552
  v_mfma_f32_32x32x16_bf16 v[48:63], v[92:95], v[196:199], v[48:63]
  v_mul_f32 v116, v20, v120
  v_mul_f32 v117, v21, v120
  ds_read_b128 v[88:91], v14 offset:24576
  s_waitcnt lgkmcnt(4)
  v_mfma_f32_32x32x16_bf16 v[48:63], v[96:99], v[200:203], v[48:63]
  v_mul_f32 v118, v22, v120
  v_mul_f32 v119, v23, v120
  ds_read_b128 v[92:95], v14 offset:25600
  v_mfma_f32_32x32x16_bf16 v[48:63], v[100:103], v[204:207], v[48:63]
  v_exp_f32 v116, v116
  ds_read_b128 v[96:99], v14 offset:26624
  v_mfma_f32_32x32x16_bf16 v[48:63], v[104:107], v[208:211], v[48:63]
  v_exp_f32 v117, v117
  ds_read_b128 v[100:103], v14 offset:27648
  s_waitcnt lgkmcnt(4)
  v_mfma_f32_32x32x16_bf16 v[48:63], v[108:111], v[212:215], v[48:63]
  v_exp_f32 v118, v118
  ds_read_b128 v[104:107], v14 offset:28672
  v_mfma_f32_32x32x16_bf16 v[48:63], v[80:83], v[216:219], v[48:63]
  v_exp_f32 v119, v119
  ds_read_b128 v[108:111], v14 offset:29696
  v_mfma_f32_32x32x16_bf16 v[48:63], v[84:87], v[220:223], v[48:63]
  v_fma_f32 v116, v116, v122, v122
  v_fma_f32 v117, v117, v122, v122
  ds_read_b128 v[80:83], v14 offset:30720
  s_waitcnt lgkmcnt(4)
  v_mfma_f32_32x32x16_bf16 v[48:63], v[88:91], v[224:227], v[48:63]
  v_fma_f32 v118, v118, v122, v122
  v_fma_f32 v119, v119, v122, v122
  ds_read_b128 v[84:87], v14 offset:31744
  v_mfma_f32_32x32x16_bf16 v[48:63], v[92:95], v[228:231], v[48:63]
  v_rcp_f32 v116, v116
  ds_read_b128 v[88:91], v15 offset:18432
  v_mfma_f32_32x32x16_bf16 v[48:63], v[96:99], v[232:235], v[48:63]
  v_rcp_f32 v117, v117
  s_barrier
  ds_read_b128 v[92:95], v14 offset:32768
  s_waitcnt lgkmcnt(4)
  v_mfma_f32_32x32x16_bf16 v[48:63], v[100:103], v[236:239], v[48:63]
  v_rcp_f32 v118, v118
  ds_read_b128 v[96:99], v14 offset:33792
  v_mfma_f32_32x32x16_bf16 v[48:63], v[104:107], v[240:243], v[48:63]
  v_rcp_f32 v119, v119
  ds_read_b128 v[100:103], v14 offset:34816
  v_mfma_f32_32x32x16_bf16 v[48:63], v[108:111], v[244:247], v[48:63]
  v_mul_f32 v116, v116, v28
  v_mul_f32 v117, v117, v29
  ds_read_b128 v[104:107], v14 offset:35840
  s_waitcnt lgkmcnt(4)
  v_mfma_f32_32x32x16_bf16 v[48:63], v[80:83], v[248:251], v[48:63]
  v_mul_f32 v118, v118, v30
  v_mul_f32 v119, v119, v31
  ds_read_b128 v[108:111], v14 offset:36864
  v_mfma_f32_32x32x16_bf16 v[48:63], v[84:87], v[252:255], v[48:63]
  v_cvt_pk_bf16_f32 v126, v116, v117
  v_cvt_pk_bf16_f32 v127, v118, v119
  ds_read_b128 v[80:83], v14 offset:37888
  v_mfma_f32_32x32x16_bf16 v[48:63], v[88:91], v[112:115], v[48:63]
  buffer_store_dwordx4 v[124:127], v2, s[12:15], s30 offen sc1
  v_mul_f32 v116, v32, v120
  ds_read_b128 v[84:87], v14 offset:38912
  s_waitcnt lgkmcnt(4)
  v_mfma_f32_32x32x16_bf16 v[64:79], v[92:95], v[128:131], 0
  v_mul_f32 v117, v33, v120
  v_mul_f32 v118, v34, v120
  ds_read_b128 v[88:91], v14 offset:39936
  v_mfma_f32_32x32x16_bf16 v[64:79], v[96:99], v[132:135], v[64:79]
  v_mul_f32 v119, v35, v120
  ds_read_b128 v[92:95], v14 offset:40960
  v_mfma_f32_32x32x16_bf16 v[64:79], v[100:103], v[136:139], v[64:79]
  v_exp_f32 v116, v116
  ds_read_b128 v[96:99], v14 offset:41984
  s_waitcnt lgkmcnt(4)
  v_mfma_f32_32x32x16_bf16 v[64:79], v[104:107], v[140:143], v[64:79]
  v_exp_f32 v117, v117
  ds_read_b128 v[100:103], v14 offset:43008
  v_mfma_f32_32x32x16_bf16 v[64:79], v[108:111], v[144:147], v[64:79]
  v_exp_f32 v118, v118
  ds_read_b128 v[104:107], v14 offset:44032
  v_mfma_f32_32x32x16_bf16 v[64:79], v[80:83], v[148:151], v[64:79]
  v_exp_f32 v119, v119
  ds_read_b128 v[108:111], v14 offset:45056
  s_waitcnt lgkmcnt(4)
  v_mfma_f32_32x32x16_bf16 v[64:79], v[84:87], v[152:155], v[64:79]
  v_fma_f32 v116, v116, v122, v122
  v_fma_f32 v117, v117, v122, v122
  ds_read_b128 v[80:83], v14 offset:46080
  v_mfma_f32_32x32x16_bf16 v[64:79], v[88:91], v[156:159], v[64:79]
  v_fma_f32 v118, v118, v122, v122
  v_fma_f32 v119, v119, v122, v122
  ds_read_b128 v[84:87], v14 offset:47104
  v_mfma_f32_32x32x16_bf16 v[64:79], v[92:95], v[160:163], v[64:79]
  v_rcp_f32 v116, v116
  ds_read_b128 v[88:91], v14 offset:48128
  s_waitcnt lgkmcnt(4)
  v_mfma_f32_32x32x16_bf16 v[64:79], v[96:99], v[164:167], v[64:79]
  v_rcp_f32 v117, v117
  ds_read_b128 v[92:95], v14 offset:49152
  v_mfma_f32_32x32x16_bf16 v[64:79], v[100:103], v[168:171], v[64:79]
  v_rcp_f32 v118, v118
  ds_read_b128 v[96:99], v14 offset:50176
  v_mfma_f32_32x32x16_bf16 v[64:79], v[104:107], v[172:175], v[64:79]
  v_rcp_f32 v119, v119
  ds_read_b128 v[100:103], v14 offset:51200
  s_waitcnt lgkmcnt(4)
  v_mfma_f32_32x32x16_bf16 v[64:79], v[108:111], v[176:179], v[64:79]
  v_mul_f32 v116, v116, v40
  v_mul_f32 v117, v117, v41
  ds_read_b128 v[104:107], v14 offset:52224
  v_mfma_f32_32x32x16_bf16 v[64:79], v[80:83], v[180:183], v[64:79]
  v_mul_f32 v118, v118, v42
  v_mul_f32 v119, v119, v43
  ds_read_b128 v[108:111], v14 offset:53248
  v_mfma_f32_32x32x16_bf16 v[64:79], v[84:87], v[184:187], v[64:79]
  v_cvt_pk_bf16_f32 v124, v116, v117
  v_cvt_pk_bf16_f32 v125, v118, v119
  ds_read_b128 v[80:83], v14 offset:54272
  s_waitcnt lgkmcnt(4)
  v_mfma_f32_32x32x16_bf16 v[64:79], v[88:91], v[188:191], v[64:79]
  v_mul_f32 v116, v36, v120
  v_mul_f32 v117, v37, v120
  ds_read_b128 v[84:87], v14 offset:55296
  v_mfma_f32_32x32x16_bf16 v[64:79], v[92:95], v[192:195], v[64:79]
  v_mul_f32 v118, v38, v120
  v_mul_f32 v119, v39, v120
  ds_read_b128 v[88:91], v14 offset:56320
  v_mfma_f32_32x32x16_bf16 v[64:79], v[96:99], v[196:199], v[64:79]
  v_exp_f32 v116, v116
  ds_read_b128 v[92:95], v14 offset:57344
  s_waitcnt lgkmcnt(4)
  v_mfma_f32_32x32x16_bf16 v[64:79], v[100:103], v[200:203], v[64:79]
  v_exp_f32 v117, v117
  ds_read_b128 v[96:99], v14 offset:58368
  v_mfma_f32_32x32x16_bf16 v[64:79], v[104:107], v[204:207], v[64:79]
  v_exp_f32 v118, v118
  ds_read_b128 v[100:103], v14 offset:59392
  v_mfma_f32_32x32x16_bf16 v[64:79], v[108:111], v[208:211], v[64:79]
  v_exp_f32 v119, v119
  ds_read_b128 v[104:107], v14 offset:60416
  s_waitcnt lgkmcnt(4)
  v_mfma_f32_32x32x16_bf16 v[64:79], v[80:83], v[212:215], v[64:79]
  v_fma_f32 v116, v116, v122, v122
  v_fma_f32 v117, v117, v122, v122
  ds_read_b128 v[108:111], v14 offset:61440
  v_mfma_f32_32x32x16_bf16 v[64:79], v[84:87], v[216:219], v[64:79]
  v_fma_f32 v118, v118, v122, v122
  v_fma_f32 v119, v119, v122, v122
  ds_read_b128 v[80:83], v14 offset:62464
  v_mfma_f32_32x32x16_bf16 v[64:79], v[88:91], v[220:223], v[64:79]
  v_rcp_f32 v116, v116
  ds_read_b128 v[84:87], v14 offset:63488
  s_waitcnt lgkmcnt(4)
  v_mfma_f32_32x32x16_bf16 v[64:79], v[92:95], v[224:227], v[64:79]
  v_rcp_f32 v117, v117
  ds_read_b128 v[88:91], v14 offset:64512
  v_mfma_f32_32x32x16_bf16 v[64:79], v[96:99], v[228:231], v[64:79]
  v_rcp_f32 v118, v118
  ds_read_b128 v[92:95], v15 offset:19456
  v_mfma_f32_32x32x16_bf16 v[64:79], v[100:103], v[232:235], v[64:79]
  v_rcp_f32 v119, v119
  s_barrier
  ds_read_b128 v[96:99], v15 offset:0
  s_waitcnt lgkmcnt(4)
  v_mfma_f32_32x32x16_bf16 v[64:79], v[104:107], v[236:239], v[64:79]
  v_mul_f32 v116, v116, v44
  v_mul_f32 v117, v117, v45
  ds_read_b128 v[100:103], v15 offset:1024
  v_mfma_f32_32x32x16_bf16 v[64:79], v[108:111], v[240:243], v[64:79]
  v_mul_f32 v118, v118, v46
  v_mul_f32 v119, v119, v47
  ds_read_b128 v[104:107], v15 offset:2048
  v_mfma_f32_32x32x16_bf16 v[64:79], v[80:83], v[244:247], v[64:79]
  v_cvt_pk_bf16_f32 v126, v116, v117
  v_cvt_pk_bf16_f32 v127, v118, v119
  ds_read_b128 v[108:111], v15 offset:3072
  s_waitcnt lgkmcnt(4)
  v_mfma_f32_32x32x16_bf16 v[64:79], v[84:87], v[248:251], v[64:79]
  buffer_store_dwordx4 v[124:127], v2, s[12:15], s30 offen offset:1024 sc1
  v_mul_f32 v116, v48, v120
  ds_read_b128 v[80:83], v15 offset:4096
  v_mfma_f32_32x32x16_bf16 v[64:79], v[88:91], v[252:255], v[64:79]
  v_mul_f32 v117, v49, v120
  v_mul_f32 v118, v50, v120
  ds_read_b128 v[84:87], v15 offset:5120
  v_mfma_f32_32x32x16_bf16 v[64:79], v[92:95], v[112:115], v[64:79]
  v_mul_f32 v119, v51, v120
  ds_read_b128 v[88:91], v15 offset:6144
  s_waitcnt lgkmcnt(4)
  v_mfma_f32_32x32x16_bf16 v[16:31], v[96:99], v[128:131], 0
  v_exp_f32 v116, v116
  ds_read_b128 v[92:95], v15 offset:7168
  v_mfma_f32_32x32x16_bf16 v[16:31], v[100:103], v[132:135], v[16:31]
  v_exp_f32 v117, v117
  ds_read_b128 v[96:99], v15 offset:8192
  v_mfma_f32_32x32x16_bf16 v[16:31], v[104:107], v[136:139], v[16:31]
  v_exp_f32 v118, v118
  ds_read_b128 v[100:103], v15 offset:9216
  s_waitcnt lgkmcnt(4)
  v_mfma_f32_32x32x16_bf16 v[16:31], v[108:111], v[140:143], v[16:31]
  v_exp_f32 v119, v119
  ds_read_b128 v[104:107], v15 offset:10240
  v_mfma_f32_32x32x16_bf16 v[16:31], v[80:83], v[144:147], v[16:31]
  v_fma_f32 v116, v116, v122, v122
  v_fma_f32 v117, v117, v122, v122
  ds_read_b128 v[108:111], v15 offset:11264
  v_mfma_f32_32x32x16_bf16 v[16:31], v[84:87], v[148:151], v[16:31]
  v_fma_f32 v118, v118, v122, v122
  v_fma_f32 v119, v119, v122, v122
  ds_read_b128 v[80:83], v15 offset:12288
  s_waitcnt lgkmcnt(4)
  v_mfma_f32_32x32x16_bf16 v[16:31], v[88:91], v[152:155], v[16:31]
  v_rcp_f32 v116, v116
  ds_read_b128 v[84:87], v15 offset:13312
  v_mfma_f32_32x32x16_bf16 v[16:31], v[92:95], v[156:159], v[16:31]
  v_rcp_f32 v117, v117
  ds_read_b128 v[88:91], v15 offset:14336
  v_mfma_f32_32x32x16_bf16 v[16:31], v[96:99], v[160:163], v[16:31]
  v_rcp_f32 v118, v118
  ds_read_b128 v[92:95], v15 offset:15360
  s_waitcnt lgkmcnt(4)
  v_mfma_f32_32x32x16_bf16 v[16:31], v[100:103], v[164:167], v[16:31]
  v_rcp_f32 v119, v119
  ds_read_b128 v[96:99], v2 offset:0
  v_mfma_f32_32x32x16_bf16 v[16:31], v[104:107], v[168:171], v[16:31]
  v_mul_f32 v116, v116, v56
  v_mul_f32 v117, v117, v57
  ds_read_b128 v[100:103], v2 offset:1024
  v_mfma_f32_32x32x16_bf16 v[16:31], v[108:111], v[172:175], v[16:31]
  v_mul_f32 v118, v118, v58
  v_mul_f32 v119, v119, v59
  ds_read_b128 v[104:107], v2 offset:2048
  s_waitcnt lgkmcnt(4)
  v_mfma_f32_32x32x16_bf16 v[16:31], v[80:83], v[176:179], v[16:31]
  v_cvt_pk_bf16_f32 v124, v116, v117
  v_cvt_pk_bf16_f32 v125, v118, v119
  ds_read_b128 v[108:111], v2 offset:3072
  v_mfma_f32_32x32x16_bf16 v[16:31], v[84:87], v[180:183], v[16:31]
  v_mul_f32 v116, v52, v120
  v_mul_f32 v117, v53, v120
  ds_read_b128 v[80:83], v2 offset:4096
  v_mfma_f32_32x32x16_bf16 v[16:31], v[88:91], v[184:187], v[16:31]
  v_mul_f32 v118, v54, v120
  v_mul_f32 v119, v55, v120
  ds_read_b128 v[84:87], v2 offset:5120
  s_waitcnt lgkmcnt(4)
  v_mfma_f32_32x32x16_bf16 v[16:31], v[92:95], v[188:191], v[16:31]
  v_exp_f32 v116, v116
  ds_read_b128 v[88:91], v2 offset:6144
  v_mfma_f32_32x32x16_bf16 v[16:31], v[96:99], v[192:195], v[16:31]
  v_exp_f32 v117, v117
  ds_read_b128 v[92:95], v2 offset:7168
  v_mfma_f32_32x32x16_bf16 v[16:31], v[100:103], v[196:199], v[16:31]
  v_exp_f32 v118, v118
  ds_read_b128 v[96:99], v2 offset:8192
  s_waitcnt lgkmcnt(4)
  v_mfma_f32_32x32x16_bf16 v[16:31], v[104:107], v[200:203], v[16:31]
  v_exp_f32 v119, v119
  ds_read_b128 v[100:103], v2 offset:9216
  v_mfma_f32_32x32x16_bf16 v[16:31], v[108:111], v[204:207], v[16:31]
  v_fma_f32 v116, v116, v122, v122
  v_fma_f32 v117, v117, v122, v122
  ds_read_b128 v[104:107], v2 offset:10240
  v_mfma_f32_32x32x16_bf16 v[16:31], v[80:83], v[208:211], v[16:31]
  v_fma_f32 v118, v118, v122, v122
  v_fma_f32 v119, v119, v122, v122
  ds_read_b128 v[108:111], v2 offset:11264
  s_waitcnt lgkmcnt(4)
  v_mfma_f32_32x32x16_bf16 v[16:31], v[84:87], v[212:215], v[16:31]
  v_rcp_f32 v116, v116
  ds_read_b128 v[80:83], v2 offset:12288
  v_mfma_f32_32x32x16_bf16 v[16:31], v[88:91], v[216:219], v[16:31]
  v_rcp_f32 v117, v117
  ds_read_b128 v[84:87], v2 offset:13312
  v_mfma_f32_32x32x16_bf16 v[16:31], v[92:95], v[220:223], v[16:31]
  v_rcp_f32 v118, v118
  ds_read_b128 v[88:91], v2 offset:14336
  s_waitcnt lgkmcnt(4)
  v_mfma_f32_32x32x16_bf16 v[16:31], v[96:99], v[224:227], v[16:31]
  v_rcp_f32 v119, v119
  ds_read_b128 v[92:95], v2 offset:15360
  v_mfma_f32_32x32x16_bf16 v[16:31], v[100:103], v[228:231], v[16:31]
  v_mul_f32 v116, v116, v60
  v_mul_f32 v117, v117, v61
  ds_read_b128 v[96:99], v15 offset:20480
  v_mfma_f32_32x32x16_bf16 v[16:31], v[104:107], v[232:235], v[16:31]
  v_mul_f32 v118, v118, v62
  v_mul_f32 v119, v119, v63
  s_barrier
  ds_read_b128 v[100:103], v2 offset:16384
  s_waitcnt lgkmcnt(4)
  v_mfma_f32_32x32x16_bf16 v[16:31], v[108:111], v[236:239], v[16:31]
  v_cvt_pk_bf16_f32 v126, v116, v117
  v_cvt_pk_bf16_f32 v127, v118, v119
  ds_read_b128 v[104:107], v2 offset:17408
  v_mfma_f32_32x32x16_bf16 v[16:31], v[80:83], v[240:243], v[16:31]
  buffer_store_dwordx4 v[124:127], v2, s[12:15], s30 offen offset:2048 sc1
  v_mul_f32 v116, v64, v120
  ds_read_b128 v[108:111], v2 offset:18432
  v_mfma_f32_32x32x16_bf16 v[16:31], v[84:87], v[244:247], v[16:31]
  v_mul_f32 v117, v65, v120
  v_mul_f32 v118, v66, v120
  ds_read_b128 v[80:83], v2 offset:19456
  s_waitcnt lgkmcnt(4)
  v_mfma_f32_32x32x16_bf16 v[16:31], v[88:91], v[248:251], v[16:31]
  v_mul_f32 v119, v67, v120
  ds_read_b128 v[84:87], v2 offset:20480
  v_mfma_f32_32x32x16_bf16 v[16:31], v[92:95], v[252:255], v[16:31]
  v_exp_f32 v116, v116
  ds_read_b128 v[88:91], v2 offset:21504
  v_mfma_f32_32x32x16_bf16 v[16:31], v[96:99], v[112:115], v[16:31]
  v_exp_f32 v117, v117
  ds_read_b128 v[92:95], v2 offset:22528
  s_waitcnt lgkmcnt(4)
  v_mfma_f32_32x32x16_bf16 v[32:47], v[100:103], v[128:131], 0
  v_exp_f32 v118, v118
  ds_read_b128 v[96:99], v2 offset:23552
  v_mfma_f32_32x32x16_bf16 v[32:47], v[104:107], v[132:135], v[32:47]
  v_exp_f32 v119, v119
  ds_read_b128 v[100:103], v2 offset:24576
  v_mfma_f32_32x32x16_bf16 v[32:47], v[108:111], v[136:139], v[32:47]
  v_fma_f32 v116, v116, v122, v122
  v_fma_f32 v117, v117, v122, v122
  ds_read_b128 v[104:107], v2 offset:25600
  s_waitcnt lgkmcnt(4)
  v_mfma_f32_32x32x16_bf16 v[32:47], v[80:83], v[140:143], v[32:47]
  v_fma_f32 v118, v118, v122, v122
  v_fma_f32 v119, v119, v122, v122
  ds_read_b128 v[108:111], v2 offset:26624
  v_mfma_f32_32x32x16_bf16 v[32:47], v[84:87], v[144:147], v[32:47]
  v_rcp_f32 v116, v116
  ds_read_b128 v[80:83], v2 offset:27648
  v_mfma_f32_32x32x16_bf16 v[32:47], v[88:91], v[148:151], v[32:47]
  v_rcp_f32 v117, v117
  ds_read_b128 v[84:87], v2 offset:28672
  s_waitcnt lgkmcnt(4)
  v_mfma_f32_32x32x16_bf16 v[32:47], v[92:95], v[152:155], v[32:47]
  v_rcp_f32 v118, v118
  ds_read_b128 v[88:91], v2 offset:29696
  v_mfma_f32_32x32x16_bf16 v[32:47], v[96:99], v[156:159], v[32:47]
  v_rcp_f32 v119, v119
  ds_read_b128 v[92:95], v2 offset:30720
  v_mfma_f32_32x32x16_bf16 v[32:47], v[100:103], v[160:163], v[32:47]
  v_mul_f32 v116, v116, v72
  v_mul_f32 v117, v117, v73
  ds_read_b128 v[96:99], v2 offset:31744
  s_waitcnt lgkmcnt(4)
  v_mfma_f32_32x32x16_bf16 v[32:47], v[104:107], v[164:167], v[32:47]
  v_mul_f32 v118, v118, v74
  v_mul_f32 v119, v119, v75
  ds_read_b128 v[100:103], v2 offset:32768
  v_mfma_f32_32x32x16_bf16 v[32:47], v[108:111], v[168:171], v[32:47]
  v_cvt_pk_bf16_f32 v124, v116, v117
  v_cvt_pk_bf16_f32 v125, v118, v119
  ds_read_b128 v[104:107], v2 offset:33792
  v_mfma_f32_32x32x16_bf16 v[32:47], v[80:83], v[172:175], v[32:47]
  v_mul_f32 v116, v68, v120
  v_mul_f32 v117, v69, v120
  ds_read_b128 v[108:111], v2 offset:34816
  s_waitcnt lgkmcnt(4)
  v_mfma_f32_32x32x16_bf16 v[32:47], v[84:87], v[176:179], v[32:47]
  v_mul_f32 v118, v70, v120
  v_mul_f32 v119, v71, v120
  ds_read_b128 v[80:83], v2 offset:35840
  v_mfma_f32_32x32x16_bf16 v[32:47], v[88:91], v[180:183], v[32:47]
  v_exp_f32 v116, v116
  ds_read_b128 v[84:87], v2 offset:36864
  v_mfma_f32_32x32x16_bf16 v[32:47], v[92:95], v[184:187], v[32:47]
  v_exp_f32 v117, v117
  ds_read_b128 v[88:91], v2 offset:37888
  s_waitcnt lgkmcnt(4)
  v_mfma_f32_32x32x16_bf16 v[32:47], v[96:99], v[188:191], v[32:47]
  v_exp_f32 v118, v118
  ds_read_b128 v[92:95], v2 offset:38912
  v_mfma_f32_32x32x16_bf16 v[32:47], v[100:103], v[192:195], v[32:47]
  v_exp_f32 v119, v119
  ds_read_b128 v[96:99], v2 offset:39936
  v_mfma_f32_32x32x16_bf16 v[32:47], v[104:107], v[196:199], v[32:47]
  v_fma_f32 v116, v116, v122, v122
  v_fma_f32 v117, v117, v122, v122
  ds_read_b128 v[100:103], v2 offset:40960
  s_waitcnt lgkmcnt(4)
  v_mfma_f32_32x32x16_bf16 v[32:47], v[108:111], v[200:203], v[32:47]
  v_fma_f32 v118, v118, v122, v122
  v_fma_f32 v119, v119, v122, v122
  ds_read_b128 v[104:107], v2 offset:41984
  v_mfma_f32_32x32x16_bf16 v[32:47], v[80:83], v[204:207], v[32:47]
  v_rcp_f32 v116, v116
  ds_read_b128 v[108:111], v2 offset:43008
  v_mfma_f32_32x32x16_bf16 v[32:47], v[84:87], v[208:211], v[32:47]
  v_rcp_f32 v117, v117
  ds_read_b128 v[80:83], v2 offset:44032
  s_waitcnt lgkmcnt(4)
  v_mfma_f32_32x32x16_bf16 v[32:47], v[88:91], v[212:215], v[32:47]
  v_rcp_f32 v118, v118
  ds_read_b128 v[84:87], v2 offset:45056
  v_mfma_f32_32x32x16_bf16 v[32:47], v[92:95], v[216:219], v[32:47]
  v_rcp_f32 v119, v119
  ds_read_b128 v[88:91], v2 offset:46080
  v_mfma_f32_32x32x16_bf16 v[32:47], v[96:99], v[220:223], v[32:47]
  v_mul_f32 v116, v116, v76
  v_mul_f32 v117, v117, v77
  ds_read_b128 v[92:95], v2 offset:47104
  s_waitcnt lgkmcnt(4)
  v_mfma_f32_32x32x16_bf16 v[32:47], v[100:103], v[224:227], v[32:47]
  v_mul_f32 v118, v118, v78
  v_mul_f32 v119, v119, v79
  ds_read_b128 v[96:99], v2 offset:48128
  v_mfma_f32_32x32x16_bf16 v[32:47], v[104:107], v[228:231], v[32:47]
  v_cvt_pk_bf16_f32 v126, v116, v117
  v_cvt_pk_bf16_f32 v127, v118, v119
  ds_read_b128 v[100:103], v15 offset:21504
  v_mfma_f32_32x32x16_bf16 v[32:47], v[108:111], v[232:235], v[32:47]
  buffer_store_dwordx4 v[124:127], v2, s[12:15], s30 offen offset:3072 sc1
  v_mul_f32 v116, v16, v120
  s_barrier
  ds_read_b128 v[104:107], v2 offset:49152
  s_waitcnt lgkmcnt(4)
  v_mfma_f32_32x32x16_bf16 v[32:47], v[80:83], v[236:239], v[32:47]
  v_mul_f32 v117, v17, v120
  v_mul_f32 v118, v18, v120
  ds_read_b128 v[108:111], v2 offset:50176
  v_mfma_f32_32x32x16_bf16 v[32:47], v[84:87], v[240:243], v[32:47]
  v_mul_f32 v119, v19, v120
  ds_read_b128 v[80:83], v2 offset:51200
  v_mfma_f32_32x32x16_bf16 v[32:47], v[88:91], v[244:247], v[32:47]
  v_exp_f32 v116, v116
  ds_read_b128 v[84:87], v2 offset:52224
  s_waitcnt lgkmcnt(4)
  v_mfma_f32_32x32x16_bf16 v[32:47], v[92:95], v[248:251], v[32:47]
  v_exp_f32 v117, v117
  ds_read_b128 v[88:91], v2 offset:53248
  v_mfma_f32_32x32x16_bf16 v[32:47], v[96:99], v[252:255], v[32:47]
  v_exp_f32 v118, v118
  ds_read_b128 v[92:95], v2 offset:54272
  v_mfma_f32_32x32x16_bf16 v[32:47], v[100:103], v[112:115], v[32:47]
  v_exp_f32 v119, v119
  ds_read_b128 v[96:99], v2 offset:55296
  s_waitcnt lgkmcnt(4)
  v_mfma_f32_32x32x16_bf16 v[48:63], v[104:107], v[128:131], 0
  v_fma_f32 v116, v116, v122, v122
  v_fma_f32 v117, v117, v122, v122
  ds_read_b128 v[100:103], v2 offset:56320
  v_mfma_f32_32x32x16_bf16 v[48:63], v[108:111], v[132:135], v[48:63]
  v_fma_f32 v118, v118, v122, v122
  v_fma_f32 v119, v119, v122, v122
  ds_read_b128 v[104:107], v2 offset:57344
  v_mfma_f32_32x32x16_bf16 v[48:63], v[80:83], v[136:139], v[48:63]
  v_rcp_f32 v116, v116
  ds_read_b128 v[108:111], v2 offset:58368
  s_waitcnt lgkmcnt(4)
  v_mfma_f32_32x32x16_bf16 v[48:63], v[84:87], v[140:143], v[48:63]
  v_rcp_f32 v117, v117
  ds_read_b128 v[80:83], v2 offset:59392
  v_mfma_f32_32x32x16_bf16 v[48:63], v[88:91], v[144:147], v[48:63]
  v_rcp_f32 v118, v118
  ds_read_b128 v[84:87], v2 offset:60416
  v_mfma_f32_32x32x16_bf16 v[48:63], v[92:95], v[148:151], v[48:63]
  v_rcp_f32 v119, v119
  ds_read_b128 v[88:91], v2 offset:61440
  s_waitcnt lgkmcnt(4)
  v_mfma_f32_32x32x16_bf16 v[48:63], v[96:99], v[152:155], v[48:63]
  v_mul_f32 v116, v116, v24
  v_mul_f32 v117, v117, v25
  ds_read_b128 v[92:95], v2 offset:62464
  v_mfma_f32_32x32x16_bf16 v[48:63], v[100:103], v[156:159], v[48:63]
  v_mul_f32 v118, v118, v26
  v_mul_f32 v119, v119, v27
  ds_read_b128 v[96:99], v2 offset:63488
  v_mfma_f32_32x32x16_bf16 v[48:63], v[104:107], v[160:163], v[48:63]
  v_cvt_pk_bf16_f32 v124, v116, v117
  v_cvt_pk_bf16_f32 v125, v118, v119
  ds_read_b128 v[100:103], v2 offset:64512
  s_waitcnt lgkmcnt(4)
  v_mfma_f32_32x32x16_bf16 v[48:63], v[108:111], v[164:167], v[48:63]
  v_mul_f32 v116, v20, v120
  v_mul_f32 v117, v21, v120
  ds_read_b128 v[104:107], v14 offset:0
  v_mfma_f32_32x32x16_bf16 v[48:63], v[80:83], v[168:171], v[48:63]
  v_mul_f32 v118, v22, v120
  v_mul_f32 v119, v23, v120
  ds_read_b128 v[108:111], v14 offset:1024
  v_mfma_f32_32x32x16_bf16 v[48:63], v[84:87], v[172:175], v[48:63]
  v_exp_f32 v116, v116
  ds_read_b128 v[80:83], v14 offset:2048
  s_waitcnt lgkmcnt(4)
  v_mfma_f32_32x32x16_bf16 v[48:63], v[88:91], v[176:179], v[48:63]
  v_exp_f32 v117, v117
  ds_read_b128 v[84:87], v14 offset:3072
  v_mfma_f32_32x32x16_bf16 v[48:63], v[92:95], v[180:183], v[48:63]
  v_exp_f32 v118, v118
  ds_read_b128 v[88:91], v14 offset:4096
  v_mfma_f32_32x32x16_bf16 v[48:63], v[96:99], v[184:187], v[48:63]
  v_exp_f32 v119, v119
  ds_read_b128 v[92:95], v14 offset:5120
  s_waitcnt lgkmcnt(4)
  v_mfma_f32_32x32x16_bf16 v[48:63], v[100:103], v[188:191], v[48:63]
  v_fma_f32 v116, v116, v122, v122
  v_fma_f32 v117, v117, v122, v122
  ds_read_b128 v[96:99], v14 offset:6144
  v_mfma_f32_32x32x16_bf16 v[48:63], v[104:107], v[192:195], v[48:63]
  v_fma_f32 v118, v118, v122, v122
  v_fma_f32 v119, v119, v122, v122
  ds_read_b128 v[100:103], v14 offset:7168
  v_mfma_f32_32x32x16_bf16 v[48:63], v[108:111], v[196:199], v[48:63]
  v_rcp_f32 v116, v116
  ds_read_b128 v[104:107], v14 offset:8192
  s_waitcnt lgkmcnt(4)
  v_mfma_f32_32x32x16_bf16 v[48:63], v[80:83], v[200:203], v[48:63]
  v_rcp_f32 v117, v117
  ds_read_b128 v[108:111], v14 offset:9216
  v_mfma_f32_32x32x16_bf16 v[48:63], v[84:87], v[204:207], v[48:63]
  v_rcp_f32 v118, v118
  ds_read_b128 v[80:83], v14 offset:10240
  v_mfma_f32_32x32x16_bf16 v[48:63], v[88:91], v[208:211], v[48:63]
  v_rcp_f32 v119, v119
  ds_read_b128 v[84:87], v14 offset:11264
  s_waitcnt lgkmcnt(4)
  v_mfma_f32_32x32x16_bf16 v[48:63], v[92:95], v[212:215], v[48:63]
  v_mul_f32 v116, v116, v28
  v_mul_f32 v117, v117, v29
  ds_read_b128 v[88:91], v14 offset:12288
  v_mfma_f32_32x32x16_bf16 v[48:63], v[96:99], v[216:219], v[48:63]
  v_mul_f32 v118, v118, v30
  v_mul_f32 v119, v119, v31
  ds_read_b128 v[92:95], v14 offset:13312
  v_mfma_f32_32x32x16_bf16 v[48:63], v[100:103], v[220:223], v[48:63]
  v_cvt_pk_bf16_f32 v126, v116, v117
  v_cvt_pk_bf16_f32 v127, v118, v119
  ds_read_b128 v[96:99], v14 offset:14336
  s_waitcnt lgkmcnt(4)
  v_mfma_f32_32x32x16_bf16 v[48:63], v[104:107], v[224:227], v[48:63]
  buffer_store_dwordx4 v[124:127], v2, s[12:15], s31 offen sc1
  v_mul_f32 v116, v32, v120
  ds_read_b128 v[100:103], v14 offset:15360
  v_mfma_f32_32x32x16_bf16 v[48:63], v[108:111], v[228:231], v[48:63]
  v_mul_f32 v117, v33, v120
  v_mul_f32 v118, v34, v120
  ds_read_b128 v[104:107], v15 offset:22528
  v_mfma_f32_32x32x16_bf16 v[48:63], v[80:83], v[232:235], v[48:63]
  v_mul_f32 v119, v35, v120
  s_waitcnt lgkmcnt(3)
  v_mfma_f32_32x32x16_bf16 v[48:63], v[84:87], v[236:239], v[48:63]
  v_exp_f32 v116, v116
  v_mfma_f32_32x32x16_bf16 v[48:63], v[88:91], v[240:243], v[48:63]
  v_exp_f32 v117, v117
  v_mfma_f32_32x32x16_bf16 v[48:63], v[92:95], v[244:247], v[48:63]
  v_exp_f32 v118, v118
  s_waitcnt lgkmcnt(0)
  v_mfma_f32_32x32x16_bf16 v[48:63], v[96:99], v[248:251], v[48:63]
  v_exp_f32 v119, v119
  v_mfma_f32_32x32x16_bf16 v[48:63], v[100:103], v[252:255], v[48:63]
  v_fma_f32 v116, v116, v122, v122
  v_fma_f32 v117, v117, v122, v122
  v_mfma_f32_32x32x16_bf16 v[48:63], v[104:107], v[112:115], v[48:63]
  v_fma_f32 v118, v118, v122, v122
  v_fma_f32 v119, v119, v122, v122
  v_rcp_f32 v116, v116
  v_rcp_f32 v117, v117
  v_rcp_f32 v118, v118
  v_rcp_f32 v119, v119
  v_mul_f32 v116, v116, v40
  v_mul_f32 v117, v117, v41
  v_mul_f32 v118, v118, v42
  v_mul_f32 v119, v119, v43
  v_cvt_pk_bf16_f32 v124, v116, v117
  v_cvt_pk_bf16_f32 v125, v118, v119
  v_mul_f32 v116, v36, v120
  v_mul_f32 v117, v37, v120
  v_mul_f32 v118, v38, v120
  v_mul_f32 v119, v39, v120
  v_exp_f32 v116, v116
  v_exp_f32 v117, v117
  v_exp_f32 v118, v118
  v_exp_f32 v119, v119
  v_fma_f32 v116, v116, v122, v122
  v_fma_f32 v117, v117, v122, v122
  v_fma_f32 v118, v118, v122, v122
  v_fma_f32 v119, v119, v122, v122
  v_rcp_f32 v116, v116
  v_rcp_f32 v117, v117
  v_rcp_f32 v118, v118
  v_rcp_f32 v119, v119
  v_mul_f32 v116, v116, v44
  v_mul_f32 v117, v117, v45
  v_mul_f32 v118, v118, v46
  v_mul_f32 v119, v119, v47
  v_cvt_pk_bf16_f32 v126, v116, v117
  v_cvt_pk_bf16_f32 v127, v118, v119
  buffer_store_dwordx4 v[124:127], v2, s[12:15], s31 offen offset:1024 sc1
  s_nop 7
  s_nop 3
  v_mul_f32 v116, v48, v120
  v_mul_f32 v117, v49, v120
  v_mul_f32 v118, v50, v120
  v_mul_f32 v119, v51, v120
  v_exp_f32 v116, v116
  v_exp_f32 v117, v117
  v_exp_f32 v118, v118
  v_exp_f32 v119, v119
  v_fma_f32 v116, v116, v122, v122
  v_fma_f32 v117, v117, v122, v122
  v_fma_f32 v118, v118, v122, v122
  v_fma_f32 v119, v119, v122, v122
  v_rcp_f32 v116, v116
  v_rcp_f32 v117, v117
  v_rcp_f32 v118, v118
  v_rcp_f32 v119, v119
  v_mul_f32 v116, v116, v56
  v_mul_f32 v117, v117, v57
  v_mul_f32 v118, v118, v58
  v_mul_f32 v119, v119, v59
  v_cvt_pk_bf16_f32 v124, v116, v117
  v_cvt_pk_bf16_f32 v125, v118, v119
  v_mul_f32 v116, v52, v120
  v_mul_f32 v117, v53, v120
  v_mul_f32 v118, v54, v120
  v_mul_f32 v119, v55, v120
  v_exp_f32 v116, v116
  v_exp_f32 v117, v117
  v_exp_f32 v118, v118
  v_exp_f32 v119, v119
  v_fma_f32 v116, v116, v122, v122
  v_fma_f32 v117, v117, v122, v122
  v_fma_f32 v118, v118, v122, v122
  v_fma_f32 v119, v119, v122, v122
  v_rcp_f32 v116, v116
  v_rcp_f32 v117, v117
  v_rcp_f32 v118, v118
  v_rcp_f32 v119, v119
  v_mul_f32 v116, v116, v60
  v_mul_f32 v117, v117, v61
  v_mul_f32 v118, v118, v62
  v_mul_f32 v119, v119, v63
  v_cvt_pk_bf16_f32 v126, v116, v117
  v_cvt_pk_bf16_f32 v127, v118, v119
  buffer_store_dwordx4 v[124:127], v2, s[12:15], s31 offen offset:2048 sc1
  s_branch p4_J
p4_L:
  s_mul_i32 s27, s45, 1792
  s_add_u32 s27, s27, 30998528
  v_and_b32 v5, 7, v1
  v_min_u32 v5, 6, v5
  v_lshlrev_b32 v5, 8, v5
  v_add_u32 v5, s27, v5
  s_mov_b32 s50, 0x40000
p4_uv:
  buffer_load_dword v6, v5, s[12:15], 0 offen offset:0 sc1
  s_waitcnt vmcnt(0)
  v_cmp_ne_u32 vcc, s60, v6
  s_cbranch_vccz p4_uve
  s_sleep 1
  s_sub_u32 s50, s50, 1
  s_cbranch_scc0 p4_uv
p4_uve:
  s_lshl_b32 s30, s7, 11
  s_mul_i32 s31, s45, 7168
  s_add_u32 s31, s31, s30
  s_add_u32 s31, s31, 30670848
  s_add_u32 m0, s30, 147456
  s_add_u32 s27, s31, 0
  buffer_load_dwordx4 v2, s[12:15], s27 offen sc1 lds
  s_add_u32 m0, s30, 148480
  s_add_u32 s27, s31, 1024
  buffer_load_dwordx4 v2, s[12:15], s27 offen sc1 lds
  s_waitcnt vmcnt(0)
  s_barrier
  s_add_u32 m0, s29, 0
  s_add_u32 s27, s28, 147456
  buffer_load_dwordx4 v2, s[12:15], s27 offen sc1 lds
  s_add_u32 m0, s29, 1024
  s_add_u32 s27, s28, 148480
  buffer_load_dwordx4 v2, s[12:15], s27 offen sc1 lds
  s_add_u32 m0, s29, 2048
  s_add_u32 s27, s28, 149504
  buffer_load_dwordx4 v2, s[12:15], s27 offen sc1 lds
  s_add_u32 m0, s29, 3072
  s_add_u32 s27, s28, 150528
  buffer_load_dwordx4 v2, s[12:15], s27 offen sc1 lds
  s_add_u32 m0, s29, 32768
  s_add_u32 s27, s28, 180224
  buffer_load_dwordx4 v2, s[12:15], s27 offen sc1 lds
  s_add_u32 m0, s29, 33792
  s_add_u32 s27, s28, 181248
  buffer_load_dwordx4 v2, s[12:15], s27 offen sc1 lds
  s_add_u32 m0, s29, 34816
  s_add_u32 s27, s28, 182272
  buffer_load_dwordx4 v2, s[12:15], s27 offen sc1 lds
  s_add_u32 m0, s29, 35840
  s_add_u32 s27, s28, 183296
  buffer_load_dwordx4 v2, s[12:15], s27 offen sc1 lds
  s_add_u32 s27, s42, 0
  buffer_load_dwordx4 v[144:147], v2, s[12:15], s27 offen sc1
  s_add_u32 s27, s42, 1024
  buffer_load_dwordx4 v[148:151], v2, s[12:15], s27 offen sc1
  s_add_u32 s27, s42, 2048
  buffer_load_dwordx4 v[152:155], v2, s[12:15], s27 offen sc1
  s_add_u32 s27, s42, 3072
  buffer_load_dwordx4 v[156:159], v2, s[12:15], s27 offen sc1
  s_add_u32 s27, s42, 4096
  buffer_load_dwordx4 v[160:163], v2, s[12:15], s27 offen sc1
  s_add_u32 s27, s42, 5120
  buffer_load_dwordx4 v[164:167], v2, s[12:15], s27 offen sc1
  s_barrier
  s_add_u32 m0, s29, 16384
  s_add_u32 s27, s28, 163840
  buffer_load_dwordx4 v2, s[12:15], s27 offen sc1 lds
  s_add_u32 m0, s29, 17408
  s_add_u32 s27, s28, 164864
  buffer_load_dwordx4 v2, s[12:15], s27 offen sc1 lds
  s_add_u32 m0, s29, 18432
  s_add_u32 s27, s28, 165888
  buffer_load_dwordx4 v2, s[12:15], s27 offen sc1 lds
  s_add_u32 m0, s29, 19456
  s_add_u32 s27, s28, 166912
  buffer_load_dwordx4 v2, s[12:15], s27 offen sc1 lds
  s_add_u32 m0, s29, 49152
  s_add_u32 s27, s28, 196608
  buffer_load_dwordx4 v2, s[12:15], s27 offen sc1 lds
  s_add_u32 m0, s29, 50176
  s_add_u32 s27, s28, 197632
  buffer_load_dwordx4 v2, s[12:15], s27 offen sc1 lds
  s_add_u32 m0, s29, 51200
  s_add_u32 s27, s28, 198656
  buffer_load_dwordx4 v2, s[12:15], s27 offen sc1 lds
  s_add_u32 m0, s29, 52224
  s_add_u32 s27, s28, 199680
  buffer_load_dwordx4 v2, s[12:15], s27 offen sc1 lds
  s_add_u32 m0, s29, 65536
  s_add_u32 s27, s28, 212992
  buffer_load_dwordx4 v2, s[12:15], s27 offen sc1 lds
  s_add_u32 m0, s29, 66560
  s_add_u32 s27, s28, 214016
  buffer_load_dwordx4 v2, s[12:15], s27 offen sc1 lds
  s_add_u32 m0, s29, 67584
  s_add_u32 s27, s28, 215040
  buffer_load_dwordx4 v2, s[12:15], s27 offen sc1 lds
  s_add_u32 m0, s29, 68608
  s_add_u32 s27, s28, 216064
  buffer_load_dwordx4 v2, s[12:15], s27 offen sc1 lds
  s_add_u32 s27, s42, 6144
  buffer_load_dwordx4 v[168:171], v2, s[12:15], s27 offen sc1
  s_add_u32 s27, s42, 7168
  buffer_load_dwordx4 v[172:175], v2, s[12:15], s27 offen sc1
  s_waitcnt vmcnt(24)
  s_barrier
  s_add_u32 m0, s29, 81920
  s_add_u32 s27, s32, 0
  buffer_load_dwordx4 v2, s[12:15], s27 offen sc1 lds
  s_add_u32 m0, s29, 82944
  s_add_u32 s27, s32, 1024
  buffer_load_dwordx4 v2, s[12:15], s27 offen sc1 lds
  s_add_u32 m0, s29, 83968
  s_add_u32 s27, s32, 2048
  buffer_load_dwordx4 v2, s[12:15], s27 offen sc1 lds
  s_add_u32 m0, s29, 84992
  s_add_u32 s27, s32, 3072
  buffer_load_dwordx4 v2, s[12:15], s27 offen sc1 lds
  s_add_u32 m0, s29, 98304
  s_add_u32 s27, s32, 4096
  buffer_load_dwordx4 v2, s[12:15], s27 offen sc1 lds
  s_add_u32 m0, s29, 99328
  s_add_u32 s27, s32, 5120
  buffer_load_dwordx4 v2, s[12:15], s27 offen sc1 lds
  s_add_u32 m0, s29, 100352
  s_add_u32 s27, s32, 6144
  buffer_load_dwordx4 v2, s[12:15], s27 offen sc1 lds
  s_add_u32 m0, s29, 101376
  s_add_u32 s27, s32, 7168
  buffer_load_dwordx4 v2, s[12:15], s27 offen sc1 lds
  s_add_u32 s27, s42, 8192
  buffer_load_dwordx4 v[176:179], v2, s[12:15], s27 offen sc1
  s_add_u32 s27, s42, 9216
  buffer_load_dwordx4 v[180:183], v2, s[12:15], s27 offen sc1
  s_add_u32 s27, s42, 10240
  buffer_load_dwordx4 v[184:187], v2, s[12:15], s27 offen sc1
  s_add_u32 s27, s42, 11264
  buffer_load_dwordx4 v[188:191], v2, s[12:15], s27 offen sc1
  s_add_u32 s27, s42, 12288
  buffer_load_dwordx4 v[192:195], v2, s[12:15], s27 offen sc1
  s_add_u32 s27, s42, 13312
  buffer_load_dwordx4 v[196:199], v2, s[12:15], s27 offen sc1
  s_waitcnt vmcnt(24)
  s_barrier
  s_add_u32 m0, s29, 114688
  s_add_u32 s27, s32, 8192
  buffer_load_dwordx4 v2, s[12:15], s27 offen sc1 lds
  s_add_u32 m0, s29, 115712
  s_add_u32 s27, s32, 9216
  buffer_load_dwordx4 v2, s[12:15], s27 offen sc1 lds
  s_add_u32 m0, s29, 116736
  s_add_u32 s27, s32, 10240
  buffer_load_dwordx4 v2, s[12:15], s27 offen sc1 lds
  s_add_u32 m0, s29, 117760
  s_add_u32 s27, s32, 11264
  buffer_load_dwordx4 v2, s[12:15], s27 offen sc1 lds
  s_add_u32 m0, s29, 131072
  s_add_u32 s27, s32, 12288
  buffer_load_dwordx4 v2, s[12:15], s27 offen sc1 lds
  s_add_u32 m0, s29, 132096
  s_add_u32 s27, s32, 13312
  buffer_load_dwordx4 v2, s[12:15], s27 offen sc1 lds
  s_add_u32 m0, s29, 133120
  s_add_u32 s27, s32, 14336
  buffer_load_dwordx4 v2, s[12:15], s27 offen sc1 lds
  s_add_u32 m0, s29, 134144
  s_add_u32 s27, s32, 15360
  buffer_load_dwordx4 v2, s[12:15], s27 offen sc1 lds
  s_add_u32 s27, s42, 14336
  buffer_load_dwordx4 v[200:203], v2, s[12:15], s27 offen sc1
  s_add_u32 s27, s42, 15360
  buffer_load_dwordx4 v[204:207], v2, s[12:15], s27 offen sc1
  s_add_u32 s27, s42, 16384
  buffer_load_dwordx4 v[208:211], v2, s[12:15], s27 offen sc1
  s_add_u32 s27, s42, 17408
  buffer_load_dwordx4 v[212:215], v2, s[12:15], s27 offen sc1
  s_add_u32 s27, s42, 18432
  buffer_load_dwordx4 v[216:219], v2, s[12:15], s27 offen sc1
  s_add_u32 s27, s42, 19456
  buffer_load_dwordx4 v[220:223], v2, s[12:15], s27 offen sc1
  s_waitcnt vmcnt(30)
  s_barrier
  s_add_u32 m0, s29, 0
  s_add_u32 s27, s32, 16384
  buffer_load_dwordx4 v2, s[12:15], s27 offen sc1 lds
  s_add_u32 m0, s29, 1024
  s_add_u32 s27, s32, 17408
  buffer_load_dwordx4 v2, s[12:15], s27 offen sc1 lds
  s_add_u32 m0, s29, 2048
  s_add_u32 s27, s32, 18432
  buffer_load_dwordx4 v2, s[12:15], s27 offen sc1 lds
  s_add_u32 m0, s29, 3072
  s_add_u32 s27, s32, 19456
  buffer_load_dwordx4 v2, s[12:15], s27 offen sc1 lds
  s_add_u32 m0, s29, 16384
  s_add_u32 s27, s32, 20480
  buffer_load_dwordx4 v2, s[12:15], s27 offen sc1 lds
  s_add_u32 m0, s29, 17408
  s_add_u32 s27, s32, 21504
  buffer_load_dwordx4 v2, s[12:15], s27 offen sc1 lds
  s_add_u32 m0, s29, 18432
  s_add_u32 s27, s32, 22528
  buffer_load_dwordx4 v2, s[12:15], s27 offen sc1 lds
  s_add_u32 m0, s29, 19456
  s_add_u32 s27, s32, 23552
  buffer_load_dwordx4 v2, s[12:15], s27 offen sc1 lds
  s_add_u32 s27, s42, 20480
  buffer_load_dwordx4 v[224:227], v2, s[12:15], s27 offen sc1
  s_add_u32 s27, s42, 21504
  buffer_load_dwordx4 v[228:231], v2, s[12:15], s27 offen sc1
  s_add_u32 s27, s42, 22528
  buffer_load_dwordx4 v[232:235], v2, s[12:15], s27 offen sc1
  s_add_u32 s27, s42, 23552
  buffer_load_dwordx4 v[236:239], v2, s[12:15], s27 offen sc1
  s_add_u32 s27, s42, 24576
  buffer_load_dwordx4 v[240:243], v2, s[12:15], s27 offen sc1
  s_add_u32 s27, s42, 25600
  buffer_load_dwordx4 v[244:247], v2, s[12:15], s27 offen sc1
  s_add_u32 s27, s42, 26624
  buffer_load_dwordx4 v[248:251], v2, s[12:15], s27 offen sc1
  s_add_u32 s27, s42, 27648
  buffer_load_dwordx4 v[252:255], v2, s[12:15], s27 offen sc1
p4_J:
  s_cmp_ge_u32 s4, 4
  s_cbranch_scc1 arr7w
  s_waitcnt vmcnt(0)
arr7w:
  s_barrier
  s_cmp_lg_u32 s4, 0
  s_cbranch_scc1 arr7
  s_mov_b64 exec, 1
  v_mov_b32 v5, 31031296
  v_mov_b32 v6, s60
  buffer_store_dword v6, v5, s[12:15], s47 offen sc1
  s_mov_b64 exec, -1
arr7:
  s_cmp_lt_u32 s4, 4
  s_cbranch_scc1 p5_ld
  s_waitcnt vmcnt(0)
p5_ld:
  s_barrier
  s_cmp_ge_u32 s4, 4
  s_cbranch_scc1 p5_a
  s_add_u32 s28, s42, 24576
  s_add_u32 s27, s28, 0
  buffer_load_dwordx4 v[240:243], v2, s[12:15], s27 offen sc1
  buffer_load_dwordx4 v[244:247], v2, s[12:15], s27 offen offset:1024 sc1
  buffer_load_dwordx4 v[248:251], v2, s[12:15], s27 offen offset:2048 sc1
  buffer_load_dwordx4 v[252:255], v2, s[12:15], s27 offen offset:3072 sc1
  s_lshl_b32 s27, s4, 12
  v_add_u32 v16, s27, v2
  v_add_u32 v17, s27, v14
  v_add_u32 v18, s27, v15
  ds_read_b128 v[144:147], v17 offset:16384
  ds_read_b128 v[148:151], v17 offset:17408
  ds_read_b128 v[152:155], v17 offset:18432
  ds_read_b128 v[156:159], v17 offset:19456
  ds_read_b128 v[160:163], v17 offset:32768
  ds_read_b128 v[164:167], v17 offset:33792
  ds_read_b128 v[168:171], v17 offset:34816
  ds_read_b128 v[172:175], v17 offset:35840
  ds_read_b128 v[176:179], v17 offset:49152
  ds_read_b128 v[180:183], v17 offset:50176
  ds_read_b128 v[184:187], v17 offset:51200
  ds_read_b128 v[188:191], v17 offset:52224
  ds_read_b128 v[192:195], v18 offset:0
  ds_read_b128 v[196:199], v18 offset:1024
  ds_read_b128 v[200:203], v18 offset:2048
  ds_read_b128 v[204:207], v18 offset:3072
  ds_read_b128 v[208:211], v16 offset:0
  ds_read_b128 v[212:215], v16 offset:1024
  ds_read_b128 v[216:219], v16 offset:2048
  ds_read_b128 v[220:223], v16 offset:3072
  ds_read_b128 v[224:227], v16 offset:16384
  ds_read_b128 v[228:231], v16 offset:17408
  ds_read_b128 v[232:235], v16 offset:18432
  ds_read_b128 v[236:239], v16 offset:19456
  s_waitcnt lgkmcnt(0)
p5_a:
  s_and_b32 s28, s25, -2
  s_mul_i32 s28, s28, 114688
  s_mul_i32 s27, s4, 14336
  s_add_u32 s28, s28, s27
  s_add_u32 s28, s28, 23068672
  s_add_u32 s29, s28, 114688
  s_add_u32 s39, s39, 10240
  s_cmp_lg_u32 s4, 3
  s_cbranch_scc1 pol8e
  s_mov_b32 s50, 0x40000
  s_lshl_b32 s27, s51, 11
  s_add_u32 s27, s27, 31031296
  v_and_b32 v5, 15, v1
  v_lshlrev_b32 v5, 7, v5
  v_add_u32 v5, s27, v5
pol8:
  buffer_load_dword v6, v5, s[12:15], 0 offen sc1
  s_waitcnt vmcnt(0)
  v_cmp_ne_u32 vcc, s60, v6
  s_cbranch_vccz pol8e
  s_sub_u32 s50, s50, 1
  s_cbranch_scc0 pol8
pol8e:
  s_barrier
  s_add_u32 s30, s28, 0
  s_add_u32 s31, s29, 0
  buffer_load_dwordx4 v[80:83], v2, s[12:15], s30 offen sc1
  buffer_load_dwordx4 v[84:87], v2, s[12:15], s31 offen sc1
  buffer_load_dwordx4 v[88:91], v2, s[12:15], s30 offen offset:1024 sc1
  buffer_load_dwordx4 v[92:95], v2, s[12:15], s31 offen offset:1024 sc1
  buffer_load_dwordx4 v[96:99], v2, s[12:15], s30 offen offset:2048 sc1
  buffer_load_dwordx4 v[100:103], v2, s[12:15], s31 offen offset:2048 sc1
  buffer_load_dwordx4 v[104:107], v2, s[12:15], s30 offen offset:3072 sc1
  buffer_load_dwordx4 v[108:111], v2, s[12:15], s31 offen offset:3072 sc1
  s_add_u32 s30, s28, 4096
  s_add_u32 s31, s29, 4096
  buffer_load_dwordx4 v[112:115], v2, s[12:15], s30 offen sc1
  buffer_load_dwordx4 v[116:119], v2, s[12:15], s31 offen sc1
  buffer_load_dwordx4 v[120:123], v2, s[12:15], s30 offen offset:1024 sc1
  buffer_load_dwordx4 v[124:127], v2, s[12:15], s31 offen offset:1024 sc1
  buffer_load_dwordx4 v[128:131], v2, s[12:15], s30 offen offset:2048 sc1
  buffer_load_dwordx4 v[132:135], v2, s[12:15], s31 offen offset:2048 sc1
  buffer_load_dwordx4 v[136:139], v2, s[12:15], s30 offen offset:3072 sc1
  buffer_load_dwordx4 v[140:143], v2, s[12:15], s31 offen offset:3072 sc1
  s_waitcnt vmcnt(14)
  v_mfma_f32_32x32x16_bf16 v[16:31], v[144:147], v[80:83], 0
  v_mfma_f32_32x32x16_bf16 v[32:47], v[148:151], v[80:83], 0
  v_mfma_f32_32x32x16_bf16 v[48:63], v[144:147], v[84:87], 0
  v_mfma_f32_32x32x16_bf16 v[64:79], v[148:151], v[84:87], 0
  s_add_u32 s30, s28, 8192
  s_add_u32 s31, s29, 8192
  buffer_load_dwordx4 v[80:83], v2, s[12:15], s30 offen sc1
  buffer_load_dwordx4 v[84:87], v2, s[12:15], s31 offen sc1
  s_waitcnt vmcnt(14)
  v_mfma_f32_32x32x16_bf16 v[16:31], v[152:155], v[88:91], v[16:31]
  v_mfma_f32_32x32x16_bf16 v[32:47], v[156:159], v[88:91], v[32:47]
  v_mfma_f32_32x32x16_bf16 v[48:63], v[152:155], v[92:95], v[48:63]
  v_mfma_f32_32x32x16_bf16 v[64:79], v[156:159], v[92:95], v[64:79]
  buffer_load_dwordx4 v[88:91], v2, s[12:15], s30 offen offset:1024 sc1
  buffer_load_dwordx4 v[92:95], v2, s[12:15], s31 offen offset:1024 sc1
  s_waitcnt vmcnt(14)
  v_mfma_f32_32x32x16_bf16 v[16:31], v[160:163], v[96:99], v[16:31]
  v_mfma_f32_32x32x16_bf16 v[32:47], v[164:167], v[96:99], v[32:47]
  v_mfma_f32_32x32x16_bf16 v[48:63], v[160:163], v[100:103], v[48:63]
  v_mfma_f32_32x32x16_bf16 v[64:79], v[164:167], v[100:103], v[64:79]
  buffer_load_dwordx4 v[96:99], v2, s[12:15], s30 offen offset:2048 sc1
  buffer_load_dwordx4 v[100:103], v2, s[12:15], s31 offen offset:2048 sc1
  s_waitcnt vmcnt(14)
  v_mfma_f32_32x32x16_bf16 v[16:31], v[168:171], v[104:107], v[16:31]
  v_mfma_f32_32x32x16_bf16 v[32:47], v[172:175], v[104:107], v[32:47]
  v_mfma_f32_32x32x16_bf16 v[48:63], v[168:171], v[108:111], v[48:63]
  v_mfma_f32_32x32x16_bf16 v[64:79], v[172:175], v[108:111], v[64:79]
  buffer_load_dwordx4 v[104:107], v2, s[12:15], s30 offen offset:3072 sc1
  buffer_load_dwordx4 v[108:111], v2, s[12:15], s31 offen offset:3072 sc1
  s_waitcnt vmcnt(14)
  v_mfma_f32_32x32x16_bf16 v[16:31], v[176:179], v[112:115], v[16:31]
  v_mfma_f32_32x32x16_bf16 v[32:47], v[180:183], v[112:115], v[32:47]
  v_mfma_f32_32x32x16_bf16 v[48:63], v[176:179], v[116:119], v[48:63]
  v_mfma_f32_32x32x16_bf16 v[64:79], v[180:183], v[116:119], v[64:79]
  s_add_u32 s30, s28, 12288
  s_add_u32 s31, s29, 12288
  buffer_load_dwordx4 v[112:115], v2, s[12:15], s30 offen sc1
  buffer_load_dwordx4 v[116:119], v2, s[12:15], s31 offen sc1
  s_waitcnt vmcnt(14)
  v_mfma_f32_32x32x16_bf16 v[16:31], v[184:187], v[120:123], v[16:31]
  v_mfma_f32_32x32x16_bf16 v[32:47], v[188:191], v[120:123], v[32:47]
  v_mfma_f32_32x32x16_bf16 v[48:63], v[184:187], v[124:127], v[48:63]
  v_mfma_f32_32x32x16_bf16 v[64:79], v[188:191], v[124:127], v[64:79]
  buffer_load_dwordx4 v[120:123], v2, s[12:15], s30 offen offset:1024 sc1
  buffer_load_dwordx4 v[124:127], v2, s[12:15], s31 offen offset:1024 sc1
  s_waitcnt vmcnt(14)
  v_mfma_f32_32x32x16_bf16 v[16:31], v[192:195], v[128:131], v[16:31]
  v_mfma_f32_32x32x16_bf16 v[32:47], v[196:199], v[128:131], v[32:47]
  v_mfma_f32_32x32x16_bf16 v[48:63], v[192:195], v[132:135], v[48:63]
  v_mfma_f32_32x32x16_bf16 v[64:79], v[196:199], v[132:135], v[64:79]
  buffer_load_dwordx4 v[144:147], v12, s[12:15], s39 offen sc1
  buffer_load_dwordx4 v[148:151], v12, s[12:15], s39 offen offset:32 sc1
  s_waitcnt vmcnt(14)
  v_mfma_f32_32x32x16_bf16 v[16:31], v[200:203], v[136:139], v[16:31]
  v_mfma_f32_32x32x16_bf16 v[32:47], v[204:207], v[136:139], v[32:47]
  v_mfma_f32_32x32x16_bf16 v[48:63], v[200:203], v[140:143], v[48:63]
  v_mfma_f32_32x32x16_bf16 v[64:79], v[204:207], v[140:143], v[64:79]
  s_waitcnt vmcnt(12)
  v_mfma_f32_32x32x16_bf16 v[16:31], v[208:211], v[80:83], v[16:31]
  v_mfma_f32_32x32x16_bf16 v[32:47], v[212:215], v[80:83], v[32:47]
  v_mfma_f32_32x32x16_bf16 v[48:63], v[208:211], v[84:87], v[48:63]
  v_mfma_f32_32x32x16_bf16 v[64:79], v[212:215], v[84:87], v[64:79]
  s_waitcnt vmcnt(10)
  v_mfma_f32_32x32x16_bf16 v[16:31], v[216:219], v[88:91], v[16:31]
  v_mfma_f32_32x32x16_bf16 v[32:47], v[220:223], v[88:91], v[32:47]
  v_mfma_f32_32x32x16_bf16 v[48:63], v[216:219], v[92:95], v[48:63]
  v_mfma_f32_32x32x16_bf16 v[64:79], v[220:223], v[92:95], v[64:79]
  s_waitcnt vmcnt(8)
  v_mfma_f32_32x32x16_bf16 v[16:31], v[224:227], v[96:99], v[16:31]
  v_mfma_f32_32x32x16_bf16 v[32:47], v[228:231], v[96:99], v[32:47]
  v_mfma_f32_32x32x16_bf16 v[48:63], v[224:227], v[100:103], v[48:63]
  v_mfma_f32_32x32x16_bf16 v[64:79], v[228:231], v[100:103], v[64:79]
  s_waitcnt vmcnt(6)
  v_mfma_f32_32x32x16_bf16 v[16:31], v[232:235], v[104:107], v[16:31]
  v_mfma_f32_32x32x16_bf16 v[32:47], v[236:239], v[104:107], v[32:47]
  v_mfma_f32_32x32x16_bf16 v[48:63], v[232:235], v[108:111], v[48:63]
  v_mfma_f32_32x32x16_bf16 v[64:79], v[236:239], v[108:111], v[64:79]
  s_waitcnt vmcnt(4)
  v_mfma_f32_32x32x16_bf16 v[16:31], v[240:243], v[112:115], v[16:31]
  v_mfma_f32_32x32x16_bf16 v[32:47], v[244:247], v[112:115], v[32:47]
  v_mfma_f32_32x32x16_bf16 v[48:63], v[240:243], v[116:119], v[48:63]
  v_mfma_f32_32x32x16_bf16 v[64:79], v[244:247], v[116:119], v[64:79]
  s_waitcnt vmcnt(2)
  v_mfma_f32_32x32x16_bf16 v[16:31], v[248:251], v[120:123], v[16:31]
  v_mfma_f32_32x32x16_bf16 v[32:47], v[252:255], v[120:123], v[32:47]
  v_mfma_f32_32x32x16_bf16 v[48:63], v[248:251], v[124:127], v[48:63]
  v_mfma_f32_32x32x16_bf16 v[64:79], v[252:255], v[124:127], v[64:79]
  s_lshl_b32 s28, s4, 11
  v_add_u32 v13, s28, v2
  v_add_u32 v14, s28, v14
  s_lshl_b32 s28, s4, 14
  v_add_u32 v15, s28, v2
  s_nop 6
  ds_write_b128 v13, v[16:19] offset:0
  ds_write_b128 v13, v[20:23] offset:1024
  ds_write_b128 v13, v[24:27] offset:32768
  ds_write_b128 v13, v[28:31] offset:33792
  ds_write_b128 v14, v[32:35] offset:0
  ds_write_b128 v14, v[36:39] offset:1024
  ds_write_b128 v14, v[40:43] offset:32768
  ds_write_b128 v14, v[44:47] offset:33792
  ds_write_b128 v13, v[48:51] offset:16384
  ds_write_b128 v13, v[52:55] offset:17408
  ds_write_b128 v13, v[56:59] offset:49152
  ds_write_b128 v13, v[60:63] offset:50176
  ds_write_b128 v14, v[64:67] offset:16384
  ds_write_b128 v14, v[68:71] offset:17408
  ds_write_b128 v14, v[72:75] offset:49152
  ds_write_b128 v14, v[76:79] offset:50176
  s_waitcnt lgkmcnt(0)
  s_barrier
  ds_read_b128 v[16:19], v15 offset:0
  ds_read_b128 v[20:23], v15 offset:1024
  ds_read_b128 v[24:27], v15 offset:2048
  ds_read_b128 v[28:31], v15 offset:3072
  ds_read_b128 v[32:35], v15 offset:4096
  ds_read_b128 v[36:39], v15 offset:5120
  ds_read_b128 v[40:43], v15 offset:6144
  ds_read_b128 v[44:47], v15 offset:7168
  ds_read_b128 v[48:51], v15 offset:8192
  ds_read_b128 v[52:55], v15 offset:9216
  ds_read_b128 v[56:59], v15 offset:10240
  ds_read_b128 v[60:63], v15 offset:11264
  ds_read_b128 v[64:67], v15 offset:12288
  ds_read_b128 v[68:71], v15 offset:13312
  ds_read_b128 v[72:75], v15 offset:14336
  ds_read_b128 v[76:79], v15 offset:15360
  s_waitcnt lgkmcnt(12)
  v_pk_add_f32 v[16:17], v[16:17], v[24:25]
  v_pk_add_f32 v[18:19], v[18:19], v[26:27]
  v_pk_add_f32 v[20:21], v[20:21], v[28:29]
  v_pk_add_f32 v[22:23], v[22:23], v[30:31]
  s_waitcnt lgkmcnt(10)
  v_pk_add_f32 v[16:17], v[16:17], v[32:33]
  v_pk_add_f32 v[18:19], v[18:19], v[34:35]
  v_pk_add_f32 v[20:21], v[20:21], v[36:37]
  v_pk_add_f32 v[22:23], v[22:23], v[38:39]
  s_waitcnt lgkmcnt(8)
  v_pk_add_f32 v[16:17], v[16:17], v[40:41]
  v_pk_add_f32 v[18:19], v[18:19], v[42:43]
  v_pk_add_f32 v[20:21], v[20:21], v[44:45]
  v_pk_add_f32 v[22:23], v[22:23], v[46:47]
  s_waitcnt lgkmcnt(6)
  v_pk_add_f32 v[16:17], v[16:17], v[48:49]
  v_pk_add_f32 v[18:19], v[18:19], v[50:51]
  v_pk_add_f32 v[20:21], v[20:21], v[52:53]
  v_pk_add_f32 v[22:23], v[22:23], v[54:55]
  s_waitcnt lgkmcnt(4)
  v_pk_add_f32 v[16:17], v[16:17], v[56:57]
  v_pk_add_f32 v[18:19], v[18:19], v[58:59]
  v_pk_add_f32 v[20:21], v[20:21], v[60:61]
  v_pk_add_f32 v[22:23], v[22:23], v[62:63]
  s_waitcnt lgkmcnt(2)
  v_pk_add_f32 v[16:17], v[16:17], v[64:65]
  v_pk_add_f32 v[18:19], v[18:19], v[66:67]
  v_pk_add_f32 v[20:21], v[20:21], v[68:69]
  v_pk_add_f32 v[22:23], v[22:23], v[70:71]
  s_waitcnt lgkmcnt(0)
  v_pk_add_f32 v[16:17], v[16:17], v[72:73]
  v_pk_add_f32 v[18:19], v[18:19], v[74:75]
  v_pk_add_f32 v[20:21], v[20:21], v[76:77]
  v_pk_add_f32 v[22:23], v[22:23], v[78:79]
  s_waitcnt vmcnt(0)
  v_lshlrev_b32 v32, 16, v8
  v_and_b32 v33, 0xffff0000, v8
  v_fma_f32 v32, v16, v144, v32
  v_fma_f32 v33, v17, v145, v33
  v_cvt_pk_bf16_f32 v8, v32, v33
  v_lshlrev_b32 v32, 16, v9
  v_and_b32 v33, 0xffff0000, v9
  v_fma_f32 v32, v18, v146, v32
  v_fma_f32 v33, v19, v147, v33
  v_cvt_pk_bf16_f32 v9, v32, v33
  v_lshlrev_b32 v32, 16, v10
  v_and_b32 v33, 0xffff0000, v10
  v_fma_f32 v32, v20, v148, v32
  v_fma_f32 v33, v21, v149, v33
  v_cvt_pk_bf16_f32 v10, v32, v33
  v_lshlrev_b32 v32, 16, v11
  v_and_b32 v33, 0xffff0000, v11
  v_fma_f32 v32, v22, v150, v32
  v_fma_f32 v33, v23, v151, v33
  v_cvt_pk_bf16_f32 v11, v32, v33
  s_nop 1
  v_permlane32_swap_b32 v8, v10
  v_permlane32_swap_b32 v9, v11
  buffer_store_dwordx4 v[8:11], v7, s[20:23], s43 offen
pb_kernel_end:
  s_endpgm
.section .rodata,"a"
.p2align 6
.amdhsa_kernel adaLN_cond__sliding_block__glu_gated_glu__prompt_kernel
  .amdhsa_next_free_vgpr 256
  .amdhsa_next_free_sgpr 102
  .amdhsa_accum_offset 256
  .amdhsa_group_segment_fixed_size 0
  .amdhsa_kernarg_size 96
  .amdhsa_user_sgpr_count 2
  .amdhsa_user_sgpr_kernarg_segment_ptr 1
  .amdhsa_system_sgpr_workgroup_id_x 1
.end_amdhsa_kernel
```
